```python
import torch

def _softmax(x, axis=-1):
    return torch.softmax(x, dim=axis)
def _gelu(x):
    return torch.nn.functional.gelu(x, approximate="tanh")
def _silu(x):
    return torch.nn.functional.silu(x)
def _sigmoid(x):
    return torch.sigmoid(x)
def _layernorm(x, axis=-1, eps=1e-5):
    m = x.mean(dim=axis, keepdim=True)
    v = x.var(dim=axis, keepdim=True, unbiased=False)
    return (x - m) / torch.sqrt(v + eps)
def _scatter_add(tgt, idx, src, axis=0):
    return tgt.clone().index_add_(axis, idx, src)
def _segment_sum(src, seg, n):
    out = torch.zeros((n,) + src.shape[1:], dtype=src.dtype)
    return out.index_add_(0, seg, src)
def _pad(x, pw):
    flat = tuple(v for pair in reversed(pw) for v in pair)
    return torch.nn.functional.pad(x, flat)

kernel_name = 'gated_mix__sliding_block_cached__dense_activation_silu__decode'

def setup_inputs():

    _w = (lambda a: (lambda t: t.to(torch.bfloat16) if t.is_floating_point() else t)(torch.as_tensor(a)))
    def _A_setup():
        B, Sq, D = 2, 1, 512
        Hq, Hkv, Sk, Dh = 32, 8, 32768, 128
        assert Hq % Hkv == 0, (Hq, Hkv)
        return {
            "x": _w((lambda *s: torch.randn(*s, dtype=torch.bfloat16) * 0.05)(B, Sq, D)),
            "k_cache": _w((lambda *s: torch.randn(*s, dtype=torch.bfloat16) * 6.4)(B, Hkv, Sk, Dh)),
            "v_cache": _w((lambda *s: torch.randn(*s, dtype=torch.bfloat16) * 0.8)(B, Hkv, Sk, Dh)),
            "wq": _w((lambda *s: torch.randn(*s, dtype=torch.bfloat16) * 6.4)(D, Hq * Dh) * (D ** -0.5)),
            "wo": _w((lambda *s: torch.randn(*s, dtype=torch.bfloat16) * 0.8)(Hq * Dh, D) * ((Hq * Dh) ** -0.5)),
        }
    _A_in = _A_setup()

    def _B_setup():
        B, S, D, F = 2, 1, 512, 1792
        return {
            "x": _w((lambda *s: torch.randn(*s, dtype=torch.bfloat16) * 0.05)(B, S, D)),
            "w1": _w((lambda *s: torch.randn(*s, dtype=torch.bfloat16) * 12.8)(D, F) * (D ** -0.5)),
            "w2": _w((lambda *s: torch.randn(*s, dtype=torch.bfloat16) * 0.4)(F, D) * (F ** -0.5)),
        }
    _B_in = _B_setup()

    return {
        "A_x": _A_in["x"],
        "A_k_cache": _A_in["k_cache"],
        "A_v_cache": _A_in["v_cache"],
        "A_wq": _A_in["wq"],
        "A_wo": _A_in["wo"],
        "B_x": _B_in["x"],
        "B_w1": _B_in["w1"],
        "B_w2": _B_in["w2"],
        "gate_w": _w((lambda *s: torch.randn(*s, dtype=torch.bfloat16) * 0.05)(512) * 16.0),
    }

def reference(A_x, A_k_cache, A_v_cache, A_wq, A_wo, B_x, B_w1, B_w2, gate_w):
    def _A_ref(x, k_cache, v_cache, wq, wo):
        B, Sq, D = x.shape
        Hq, Dh = 32, 128
        Hkv, Sk = k_cache.shape[1], k_cache.shape[2]
        W = min(4096, max(256, Sk // 4))
        rep = Hq // Hkv
        q = (lambda x, *d: x.permute(*d))((x @ wq).reshape(B, Sq, Hq, Dh), 0, 2, 1, 3)
        k = (lambda x, n, axis: torch.repeat_interleave(x, n, dim=axis))(k_cache[:, :, Sk - W:, :], rep, axis=1)
        v = (lambda x, n, axis: torch.repeat_interleave(x, n, dim=axis))(v_cache[:, :, Sk - W:, :], rep, axis=1)
        scores = torch.einsum("bhqd,bhkd->bhqk", q, k) * (Dh ** -0.5)
        p = _softmax(scores, axis=-1)
        o = torch.einsum("bhqk,bhkd->bhqd", p, v)
        return (lambda x, *d: x.permute(*d))(o, 0, 2, 1, 3).reshape(B, Sq, Hq * Dh) @ wo

    def _B_ref(x, w1, w2):
        h = torch.einsum("bsd,df->bsf", x, w1)
        h = _silu(h)
        out = torch.einsum("bsf,fd->bsd", h, w2)
        return out

    x = A_x
    g = _sigmoid((x * gate_w).sum(-1, keepdims=True))
    a = _A_ref(x, A_k_cache, A_v_cache, A_wq, A_wo)
    b = _B_ref(x, B_w1, B_w2)
    return g * a + (1 - g) * b
```

```asm
; @launch grid=(256,1,1) block=(384,1,1) lds=163840
.amdgcn_target "amdgcn-amd-amdhsa--gfx950"
.text
.globl gated_mix__sliding_block_cached__dense_activation_silu__decode_kernel
.p2align 8
.type gated_mix__sliding_block_cached__dense_activation_silu__decode_kernel,@function
gated_mix__sliding_block_cached__dense_activation_silu__decode_kernel:
  s_cmp_ge_u32 s2, 256
  s_cbranch_scc1 L_end
  s_load_dwordx16 s[4:19], s[0:1], 0
  s_load_dwordx8 s[20:27], s[0:1], 64
  v_lshrrev_b32 v1, 6, v0
  v_and_b32 v0, 63, v0
  s_and_b32 s29, s2, 7
  v_readfirstlane_b32 s28, v1
  s_lshr_b32 s30, s2, 3
  s_lshr_b32 s31, s30, 4
  s_and_b32 s32, s30, 15
  s_lshr_b32 s33, s30, 3
  s_and_b32 s34, s30, 7
  s_xor_b32 s38, s34, 4
  s_and_b32 s3, s30, 3
  s_lshr_b32 s41, s29, 2
  s_mul_i32 s40, s29, 3
  s_add_u32 s40, s40, 4
  s_lshl_b32 s42, s29, 2
  s_min_u32 s40, s40, s42
  s_xor_b32 s42, s41, 1
  s_add_u32 s42, s42, s30
  s_and_b32 s3, s42, 3
  s_sub_u32 s41, 4, s41
  s_cmp_eq_u32 s28, 4
  s_cbranch_scc1 L_loader
  s_barrier
  s_cmp_lt_u32 s28, 4
  s_cbranch_scc1 L_main
  s_branch L_aux
L_loader:
  v_lshlrev_b32 v15, 2, v0
  v_add_u32 v15, 160768, v15
  v_mov_b32 v1, 0
  ds_write_b32 v15, v1
  s_mov_b64 exec, 0xffff
  ds_write_b32 v15, v1 offset:256
  v_mov_b32 v1, -1
  ds_write_b32 v15, v1 offset:320
  s_mov_b64 exec, -1
  v_lshlrev_b32 v3, 4, v0
  v_lshrrev_b32 v4, 3, v0
  v_and_b32 v5, 7, v0
  v_and_b32 v6, 2, v4
  v_xor_b32 v5, v5, v6
  v_lshlrev_b32 v5, 4, v5
  v_xor_b32 v6, 64, v5
  v_lshl_add_u32 v26, v4, 13, v5
  v_lshl_add_u32 v27, v4, 13, v6
  s_lshl_b32 s44, s33, 20
  s_lshl_b32 s45, s29, 10
  s_add_u32 s44, s44, s45
  s_lshl_b32 s45, s34, 7
  s_add_u32 s44, s44, s45
  s_waitcnt lgkmcnt(0)
  s_barrier
  s_load_dword s35, s[26:27], 0
  s_mov_b32 s84, s4
  s_mov_b32 s85, s5
  s_mov_b32 s86, 2048
  s_mov_b32 s87, 0x20000
  s_mov_b32 s88, s20
  s_mov_b32 s89, s21
  s_mov_b32 s90, 1024
  s_mov_b32 s91, 0x20000
  s_mov_b32 m0, 155648
  s_nop 0
  buffer_load_dwordx4 v3, s[84:87], 0 offen lds
  buffer_load_dwordx4 v3, s[84:87], 0 offen offset:1024 lds
  s_mov_b32 m0, 157696
  s_nop 0
  buffer_load_dwordx4 v3, s[88:91], 0 offen lds
  s_add_u32 s68, s10, s44
  s_addc_u32 s69, s11, 0
  s_mov_b32 s70, 1040512
  s_mov_b32 s71, 0x20000
  s_mov_b32 m0, 114688
  s_mov_b32 s52, 0
  s_mov_b32 s53, 65536
  buffer_load_dwordx4 v26, s[68:71], s52 offen nt lds
  s_add_u32 m0, m0, 0x400
  s_add_u32 s52, s52, s53
  buffer_load_dwordx4 v27, s[68:71], s52 offen nt lds
  s_add_u32 m0, m0, 0x400
  s_add_u32 s52, s52, s53
  buffer_load_dwordx4 v26, s[68:71], s52 offen nt lds
  s_add_u32 m0, m0, 0x400
  s_add_u32 s52, s52, s53
  buffer_load_dwordx4 v27, s[68:71], s52 offen nt lds
  s_add_u32 m0, m0, 0x400
  s_add_u32 s52, s52, s53
  buffer_load_dwordx4 v26, s[68:71], s52 offen nt lds
  s_add_u32 m0, m0, 0x400
  s_add_u32 s52, s52, s53
  buffer_load_dwordx4 v27, s[68:71], s52 offen nt lds
  s_add_u32 m0, m0, 0x400
  s_add_u32 s52, s52, s53
  buffer_load_dwordx4 v26, s[68:71], s52 offen nt lds
  s_add_u32 m0, m0, 0x400
  s_add_u32 s52, s52, s53
  buffer_load_dwordx4 v27, s[68:71], s52 offen nt lds
  s_add_u32 m0, m0, 0x400
  s_add_u32 s52, s52, s53
  buffer_load_dwordx4 v26, s[68:71], s52 offen nt lds
  s_add_u32 m0, m0, 0x400
  s_add_u32 s52, s52, s53
  buffer_load_dwordx4 v27, s[68:71], s52 offen nt lds
  s_add_u32 m0, m0, 0x400
  s_add_u32 s52, s52, s53
  buffer_load_dwordx4 v26, s[68:71], s52 offen nt lds
  s_add_u32 m0, m0, 0x400
  s_add_u32 s52, s52, s53
  buffer_load_dwordx4 v27, s[68:71], s52 offen nt lds
  s_add_u32 m0, m0, 0x400
  s_add_u32 s52, s52, s53
  buffer_load_dwordx4 v26, s[68:71], s52 offen nt lds
  s_add_u32 m0, m0, 0x400
  s_add_u32 s52, s52, s53
  buffer_load_dwordx4 v27, s[68:71], s52 offen nt lds
  s_add_u32 m0, m0, 0x400
  s_add_u32 s52, s52, s53
  buffer_load_dwordx4 v26, s[68:71], s52 offen nt lds
  s_add_u32 m0, m0, 0x400
  s_add_u32 s52, s52, s53
  buffer_load_dwordx4 v27, s[68:71], s52 offen nt lds
  s_mov_b32 s48, s3
  s_lshr_b32 s49, s30, 2
  s_mul_i32 s49, s49, 229376
  s_cmp_lt_u32 s48, s41
  s_cselect_b32 s50, 225920, 0
  s_add_u32 s48, s48, s40
  s_lshl_b32 s48, s48, 7
  s_add_u32 s48, s48, s49
  s_cmp_eq_u32 s50, 0
  s_cselect_b32 s48, 0, s48
  s_add_u32 s80, s16, s48
  s_addc_u32 s81, s17, 0
  s_mov_b32 s82, s50
  s_mov_b32 s83, 0x20000
  v_mul_u32_u24 v7, 3584, v4
  v_add_u32 v30, v7, v5
  v_add_u32 v31, v7, v6
  s_mov_b32 m0, 106496
  s_mov_b32 s52, 0
  s_mov_b32 s53, 28672
  buffer_load_dwordx4 v30, s[80:83], s52 offen nt lds
  s_add_u32 m0, m0, 0x400
  s_add_u32 s52, s52, s53
  buffer_load_dwordx4 v31, s[80:83], s52 offen nt lds
  s_add_u32 m0, m0, 0x400
  s_add_u32 s52, s52, s53
  buffer_load_dwordx4 v30, s[80:83], s52 offen nt lds
  s_add_u32 m0, m0, 0x400
  s_add_u32 s52, s52, s53
  buffer_load_dwordx4 v31, s[80:83], s52 offen nt lds
  s_add_u32 m0, m0, 0x400
  s_add_u32 s52, s52, s53
  buffer_load_dwordx4 v30, s[80:83], s52 offen nt lds
  s_add_u32 m0, m0, 0x400
  s_add_u32 s52, s52, s53
  buffer_load_dwordx4 v31, s[80:83], s52 offen nt lds
  s_add_u32 m0, m0, 0x400
  s_add_u32 s52, s52, s53
  buffer_load_dwordx4 v30, s[80:83], s52 offen nt lds
  s_add_u32 m0, m0, 0x400
  s_add_u32 s52, s52, s53
  buffer_load_dwordx4 v31, s[80:83], s52 offen nt lds
  s_lshl_b32 s43, s31, 3
  s_add_u32 s43, s43, s29
  s_lshl_b32 s43, s43, 23
  s_lshl_b32 s47, s32, 16
  s_add_u32 s43, s43, s47
  s_add_u32 s43, s43, 0x700000
  s_mul_i32 s51, s2, 20
  s_and_b32 s51, s51, 60
  s_lshl_b32 s51, s51, 10
  v_lshrrev_b32 v7, 4, v0
  v_and_b32 v8, 15, v0
  v_add_u32 v9, 0, v7
  v_xor_b32 v9, v9, v8
  v_lshlrev_b32 v9, 4, v9
  v_lshl_add_u32 v20, v7, 8, v9
  v_add_u32 v9, 4, v7
  v_xor_b32 v9, v9, v8
  v_lshlrev_b32 v9, 4, v9
  v_lshl_add_u32 v21, v7, 8, v9
  v_add_u32 v9, 8, v7
  v_xor_b32 v9, v9, v8
  v_lshlrev_b32 v9, 4, v9
  v_lshl_add_u32 v22, v7, 8, v9
  v_add_u32 v9, 12, v7
  v_xor_b32 v9, v9, v8
  v_lshlrev_b32 v9, 4, v9
  v_lshl_add_u32 v23, v7, 8, v9
  s_add_u32 s60, s6, s43
  s_addc_u32 s61, s7, 0
  s_mov_b32 s62, 65536
  s_mov_b32 s63, 0x20000
  s_add_u32 s52, s51, 0
  s_and_b32 s52, s52, 0xffff
  s_mov_b32 m0, 0
  s_nop 0
  buffer_load_dwordx4 v20, s[60:63], s52 offen offset:0 nt lds
  buffer_load_dwordx4 v21, s[60:63], s52 offen offset:1024 nt lds
  buffer_load_dwordx4 v22, s[60:63], s52 offen offset:2048 nt lds
  buffer_load_dwordx4 v23, s[60:63], s52 offen offset:3072 nt lds
  s_waitcnt vmcnt(28)
  v_mov_b32 v8, 1
  ds_write_b32 v15, v8
  s_add_u32 s52, s51, 4096
  s_and_b32 s52, s52, 0xffff
  s_mov_b32 m0, 4096
  s_nop 0
  buffer_load_dwordx4 v20, s[60:63], s52 offen offset:0 nt lds
  buffer_load_dwordx4 v21, s[60:63], s52 offen offset:1024 nt lds
  buffer_load_dwordx4 v22, s[60:63], s52 offen offset:2048 nt lds
  buffer_load_dwordx4 v23, s[60:63], s52 offen offset:3072 nt lds
  s_waitcnt vmcnt(28)
  v_mov_b32 v8, 2
  ds_write_b32 v15, v8
  s_add_u32 s52, s51, 8192
  s_and_b32 s52, s52, 0xffff
  s_mov_b32 m0, 8192
  s_nop 0
  buffer_load_dwordx4 v20, s[60:63], s52 offen offset:0 nt lds
  buffer_load_dwordx4 v21, s[60:63], s52 offen offset:1024 nt lds
  buffer_load_dwordx4 v22, s[60:63], s52 offen offset:2048 nt lds
  buffer_load_dwordx4 v23, s[60:63], s52 offen offset:3072 nt lds
  s_waitcnt vmcnt(28)
  v_mov_b32 v8, 3
  ds_write_b32 v15, v8
  s_add_u32 s52, s51, 12288
  s_and_b32 s52, s52, 0xffff
  s_mov_b32 m0, 12288
  s_nop 0
  buffer_load_dwordx4 v20, s[60:63], s52 offen offset:0 nt lds
  buffer_load_dwordx4 v21, s[60:63], s52 offen offset:1024 nt lds
  buffer_load_dwordx4 v22, s[60:63], s52 offen offset:2048 nt lds
  buffer_load_dwordx4 v23, s[60:63], s52 offen offset:3072 nt lds
  s_waitcnt vmcnt(28)
  v_mov_b32 v8, 4
  ds_write_b32 v15, v8
  s_add_u32 s52, s51, 16384
  s_and_b32 s52, s52, 0xffff
  s_mov_b32 m0, 16384
  s_nop 0
  buffer_load_dwordx4 v20, s[60:63], s52 offen offset:0 nt lds
  buffer_load_dwordx4 v21, s[60:63], s52 offen offset:1024 nt lds
  buffer_load_dwordx4 v22, s[60:63], s52 offen offset:2048 nt lds
  buffer_load_dwordx4 v23, s[60:63], s52 offen offset:3072 nt lds
  s_waitcnt vmcnt(28)
  v_mov_b32 v8, 5
  ds_write_b32 v15, v8
  s_add_u32 s52, s51, 20480
  s_and_b32 s52, s52, 0xffff
  s_mov_b32 m0, 20480
  s_nop 0
  buffer_load_dwordx4 v20, s[60:63], s52 offen offset:0 nt lds
  buffer_load_dwordx4 v21, s[60:63], s52 offen offset:1024 nt lds
  buffer_load_dwordx4 v22, s[60:63], s52 offen offset:2048 nt lds
  buffer_load_dwordx4 v23, s[60:63], s52 offen offset:3072 nt lds
  s_waitcnt vmcnt(28)
  v_mov_b32 v8, 6
  ds_write_b32 v15, v8
  s_add_u32 s52, s51, 24576
  s_and_b32 s52, s52, 0xffff
  s_mov_b32 m0, 24576
  s_nop 0
  buffer_load_dwordx4 v20, s[60:63], s52 offen offset:0 nt lds
  buffer_load_dwordx4 v21, s[60:63], s52 offen offset:1024 nt lds
  buffer_load_dwordx4 v22, s[60:63], s52 offen offset:2048 nt lds
  buffer_load_dwordx4 v23, s[60:63], s52 offen offset:3072 nt lds
  s_waitcnt vmcnt(28)
  v_mov_b32 v8, 7
  ds_write_b32 v15, v8
  s_add_u32 s52, s51, 28672
  s_and_b32 s52, s52, 0xffff
  s_mov_b32 m0, 28672
  s_nop 0
  buffer_load_dwordx4 v20, s[60:63], s52 offen offset:0 nt lds
  buffer_load_dwordx4 v21, s[60:63], s52 offen offset:1024 nt lds
  buffer_load_dwordx4 v22, s[60:63], s52 offen offset:2048 nt lds
  buffer_load_dwordx4 v23, s[60:63], s52 offen offset:3072 nt lds
  s_waitcnt vmcnt(28)
  v_mov_b32 v8, 8
  ds_write_b32 v15, v8
  s_add_u32 s52, s51, 32768
  s_and_b32 s52, s52, 0xffff
  s_mov_b32 m0, 32768
  s_nop 0
  buffer_load_dwordx4 v20, s[60:63], s52 offen offset:0 nt lds
  buffer_load_dwordx4 v21, s[60:63], s52 offen offset:1024 nt lds
  buffer_load_dwordx4 v22, s[60:63], s52 offen offset:2048 nt lds
  buffer_load_dwordx4 v23, s[60:63], s52 offen offset:3072 nt lds
  s_waitcnt vmcnt(28)
  v_mov_b32 v8, 9
  ds_write_b32 v15, v8
  s_add_u32 s52, s51, 36864
  s_and_b32 s52, s52, 0xffff
  s_mov_b32 m0, 36864
  s_nop 0
  buffer_load_dwordx4 v20, s[60:63], s52 offen offset:0 nt lds
  buffer_load_dwordx4 v21, s[60:63], s52 offen offset:1024 nt lds
  buffer_load_dwordx4 v22, s[60:63], s52 offen offset:2048 nt lds
  buffer_load_dwordx4 v23, s[60:63], s52 offen offset:3072 nt lds
  s_waitcnt vmcnt(28)
  v_mov_b32 v8, 10
  ds_write_b32 v15, v8
  s_add_u32 s52, s51, 40960
  s_and_b32 s52, s52, 0xffff
  s_mov_b32 m0, 40960
  s_nop 0
  buffer_load_dwordx4 v20, s[60:63], s52 offen offset:0 nt lds
  buffer_load_dwordx4 v21, s[60:63], s52 offen offset:1024 nt lds
  buffer_load_dwordx4 v22, s[60:63], s52 offen offset:2048 nt lds
  buffer_load_dwordx4 v23, s[60:63], s52 offen offset:3072 nt lds
  s_waitcnt vmcnt(28)
  v_mov_b32 v8, 11
  ds_write_b32 v15, v8
  s_add_u32 s52, s51, 45056
  s_and_b32 s52, s52, 0xffff
  s_mov_b32 m0, 45056
  s_nop 0
  buffer_load_dwordx4 v20, s[60:63], s52 offen offset:0 nt lds
  buffer_load_dwordx4 v21, s[60:63], s52 offen offset:1024 nt lds
  buffer_load_dwordx4 v22, s[60:63], s52 offen offset:2048 nt lds
  buffer_load_dwordx4 v23, s[60:63], s52 offen offset:3072 nt lds
  s_waitcnt vmcnt(28)
  v_mov_b32 v8, 12
  ds_write_b32 v15, v8
  s_add_u32 s52, s51, 49152
  s_and_b32 s52, s52, 0xffff
  s_mov_b32 m0, 49152
  s_nop 0
  buffer_load_dwordx4 v20, s[60:63], s52 offen offset:0 nt lds
  buffer_load_dwordx4 v21, s[60:63], s52 offen offset:1024 nt lds
  buffer_load_dwordx4 v22, s[60:63], s52 offen offset:2048 nt lds
  buffer_load_dwordx4 v23, s[60:63], s52 offen offset:3072 nt lds
  s_waitcnt vmcnt(28)
  v_mov_b32 v8, 13
  ds_write_b32 v15, v8
  s_add_u32 s52, s51, 53248
  s_and_b32 s52, s52, 0xffff
  s_mov_b32 m0, 53248
  s_nop 0
  buffer_load_dwordx4 v20, s[60:63], s52 offen offset:0 nt lds
  buffer_load_dwordx4 v21, s[60:63], s52 offen offset:1024 nt lds
  buffer_load_dwordx4 v22, s[60:63], s52 offen offset:2048 nt lds
  buffer_load_dwordx4 v23, s[60:63], s52 offen offset:3072 nt lds
  s_waitcnt vmcnt(28)
  v_mov_b32 v8, 14
  ds_write_b32 v15, v8
  s_add_u32 s52, s51, 57344
  s_and_b32 s52, s52, 0xffff
  s_mov_b32 m0, 57344
  s_nop 0
  buffer_load_dwordx4 v20, s[60:63], s52 offen offset:0 nt lds
  buffer_load_dwordx4 v21, s[60:63], s52 offen offset:1024 nt lds
  buffer_load_dwordx4 v22, s[60:63], s52 offen offset:2048 nt lds
  buffer_load_dwordx4 v23, s[60:63], s52 offen offset:3072 nt lds
  s_waitcnt vmcnt(28)
  v_mov_b32 v8, 15
  ds_write_b32 v15, v8
  s_add_u32 s52, s51, 61440
  s_and_b32 s52, s52, 0xffff
  s_mov_b32 m0, 61440
  s_nop 0
  buffer_load_dwordx4 v20, s[60:63], s52 offen offset:0 nt lds
  buffer_load_dwordx4 v21, s[60:63], s52 offen offset:1024 nt lds
  buffer_load_dwordx4 v22, s[60:63], s52 offen offset:2048 nt lds
  buffer_load_dwordx4 v23, s[60:63], s52 offen offset:3072 nt lds
  s_waitcnt vmcnt(28)
  v_mov_b32 v8, 16
  ds_write_b32 v15, v8
  v_lshrrev_b32 v7, 4, v0
  v_and_b32 v8, 15, v0
  v_add_u32 v9, 0, v7
  v_lshlrev_b32 v9, 1, v9
  v_xor_b32 v9, v9, v8
  v_lshlrev_b32 v9, 4, v9
  v_lshl_add_u32 v24, v7, 8, v9
  v_add_u32 v9, 4, v7
  v_lshlrev_b32 v9, 1, v9
  v_xor_b32 v9, v9, v8
  v_lshlrev_b32 v9, 4, v9
  v_lshl_add_u32 v25, v7, 8, v9
  s_add_u32 s64, s8, s43
  s_addc_u32 s65, s9, 0
  s_mov_b32 s66, 65536
  s_mov_b32 s67, 0x20000
  s_add_u32 s52, s51, 0
  s_and_b32 s52, s52, 0xffff
  s_mov_b32 m0, 65536
  s_nop 0
  buffer_load_dwordx4 v24, s[64:67], s52 offen offset:0 nt lds
  buffer_load_dwordx4 v25, s[64:67], s52 offen offset:1024 nt lds
  buffer_load_dwordx4 v24, s[64:67], s52 offen offset:2048 nt lds
  buffer_load_dwordx4 v25, s[64:67], s52 offen offset:3072 nt lds
  s_waitcnt vmcnt(28)
  v_mov_b32 v8, 17
  ds_write_b32 v15, v8
  s_add_u32 s52, s51, 4096
  s_and_b32 s52, s52, 0xffff
  s_mov_b32 m0, 69632
  s_nop 0
  buffer_load_dwordx4 v24, s[64:67], s52 offen offset:0 nt lds
  buffer_load_dwordx4 v25, s[64:67], s52 offen offset:1024 nt lds
  buffer_load_dwordx4 v24, s[64:67], s52 offen offset:2048 nt lds
  buffer_load_dwordx4 v25, s[64:67], s52 offen offset:3072 nt lds
  s_waitcnt vmcnt(28)
  v_mov_b32 v8, 18
  ds_write_b32 v15, v8
  s_add_u32 s52, s51, 8192
  s_and_b32 s52, s52, 0xffff
  s_mov_b32 m0, 73728
  s_nop 0
  buffer_load_dwordx4 v24, s[64:67], s52 offen offset:0 nt lds
  buffer_load_dwordx4 v25, s[64:67], s52 offen offset:1024 nt lds
  buffer_load_dwordx4 v24, s[64:67], s52 offen offset:2048 nt lds
  buffer_load_dwordx4 v25, s[64:67], s52 offen offset:3072 nt lds
  s_waitcnt vmcnt(28)
  v_mov_b32 v8, 19
  ds_write_b32 v15, v8
  s_add_u32 s52, s51, 12288
  s_and_b32 s52, s52, 0xffff
  s_mov_b32 m0, 77824
  s_nop 0
  buffer_load_dwordx4 v24, s[64:67], s52 offen offset:0 nt lds
  buffer_load_dwordx4 v25, s[64:67], s52 offen offset:1024 nt lds
  buffer_load_dwordx4 v24, s[64:67], s52 offen offset:2048 nt lds
  buffer_load_dwordx4 v25, s[64:67], s52 offen offset:3072 nt lds
  s_waitcnt vmcnt(28)
  v_mov_b32 v8, 20
  ds_write_b32 v15, v8
  s_add_u32 s52, s51, 16384
  s_and_b32 s52, s52, 0xffff
  s_mov_b32 m0, 81920
  s_nop 0
  buffer_load_dwordx4 v24, s[64:67], s52 offen offset:0 nt lds
  buffer_load_dwordx4 v25, s[64:67], s52 offen offset:1024 nt lds
  buffer_load_dwordx4 v24, s[64:67], s52 offen offset:2048 nt lds
  buffer_load_dwordx4 v25, s[64:67], s52 offen offset:3072 nt lds
  s_waitcnt vmcnt(28)
  v_mov_b32 v8, 21
  ds_write_b32 v15, v8
  s_add_u32 s52, s51, 20480
  s_and_b32 s52, s52, 0xffff
  s_mov_b32 m0, 86016
  s_nop 0
  buffer_load_dwordx4 v24, s[64:67], s52 offen offset:0 nt lds
  buffer_load_dwordx4 v25, s[64:67], s52 offen offset:1024 nt lds
  buffer_load_dwordx4 v24, s[64:67], s52 offen offset:2048 nt lds
  buffer_load_dwordx4 v25, s[64:67], s52 offen offset:3072 nt lds
  s_waitcnt vmcnt(28)
  v_mov_b32 v8, 22
  ds_write_b32 v15, v8
  s_add_u32 s52, s51, 24576
  s_and_b32 s52, s52, 0xffff
  s_mov_b32 m0, 90112
  s_nop 0
  buffer_load_dwordx4 v24, s[64:67], s52 offen offset:0 nt lds
  buffer_load_dwordx4 v25, s[64:67], s52 offen offset:1024 nt lds
  buffer_load_dwordx4 v24, s[64:67], s52 offen offset:2048 nt lds
  buffer_load_dwordx4 v25, s[64:67], s52 offen offset:3072 nt lds
  s_waitcnt vmcnt(28)
  v_mov_b32 v8, 23
  ds_write_b32 v15, v8
  s_add_u32 s52, s51, 28672
  s_and_b32 s52, s52, 0xffff
  s_mov_b32 m0, 94208
  s_nop 0
  buffer_load_dwordx4 v24, s[64:67], s52 offen offset:0 nt lds
  buffer_load_dwordx4 v25, s[64:67], s52 offen offset:1024 nt lds
  buffer_load_dwordx4 v24, s[64:67], s52 offen offset:2048 nt lds
  buffer_load_dwordx4 v25, s[64:67], s52 offen offset:3072 nt lds
  s_waitcnt vmcnt(28)
  v_mov_b32 v8, 24
  ds_write_b32 v15, v8
  s_add_u32 s52, s51, 32768
  s_and_b32 s52, s52, 0xffff
  s_mov_b32 m0, 98304
  s_nop 0
  buffer_load_dwordx4 v24, s[64:67], s52 offen offset:0 nt lds
  buffer_load_dwordx4 v25, s[64:67], s52 offen offset:1024 nt lds
  buffer_load_dwordx4 v24, s[64:67], s52 offen offset:2048 nt lds
  buffer_load_dwordx4 v25, s[64:67], s52 offen offset:3072 nt lds
  s_waitcnt vmcnt(28)
  v_mov_b32 v8, 25
  ds_write_b32 v15, v8
  s_add_u32 s52, s51, 36864
  s_and_b32 s52, s52, 0xffff
  s_mov_b32 m0, 102400
  s_nop 0
  buffer_load_dwordx4 v24, s[64:67], s52 offen offset:0 nt lds
  buffer_load_dwordx4 v25, s[64:67], s52 offen offset:1024 nt lds
  buffer_load_dwordx4 v24, s[64:67], s52 offen offset:2048 nt lds
  buffer_load_dwordx4 v25, s[64:67], s52 offen offset:3072 nt lds
  s_waitcnt vmcnt(28)
  v_mov_b32 v8, 26
  ds_write_b32 v15, v8
  v_mov_b32 v7, 161056
  s_mov_b32 s93, 2097152
L_wf_1:
  s_sub_u32 s93, s93, 1
  s_cbranch_scc1 L_wfd_2
  ds_read_b32 v9, v7
  s_waitcnt lgkmcnt(0)
  v_readfirstlane_b32 s53, v9
  s_cmp_ge_u32 s53, 4
  s_cbranch_scc0 L_wf_1
L_wfd_2:
  s_add_u32 s52, s51, 40960
  s_and_b32 s52, s52, 0xffff
  s_mov_b32 m0, 106496
  s_nop 0
  buffer_load_dwordx4 v24, s[64:67], s52 offen offset:0 nt lds
  buffer_load_dwordx4 v25, s[64:67], s52 offen offset:1024 nt lds
  buffer_load_dwordx4 v24, s[64:67], s52 offen offset:2048 nt lds
  buffer_load_dwordx4 v25, s[64:67], s52 offen offset:3072 nt lds
  s_waitcnt vmcnt(28)
  v_mov_b32 v8, 27
  ds_write_b32 v15, v8
  s_add_u32 s52, s51, 45056
  s_and_b32 s52, s52, 0xffff
  s_mov_b32 m0, 110592
  s_nop 0
  buffer_load_dwordx4 v24, s[64:67], s52 offen offset:0 nt lds
  buffer_load_dwordx4 v25, s[64:67], s52 offen offset:1024 nt lds
  buffer_load_dwordx4 v24, s[64:67], s52 offen offset:2048 nt lds
  buffer_load_dwordx4 v25, s[64:67], s52 offen offset:3072 nt lds
  s_waitcnt vmcnt(28)
  v_mov_b32 v8, 28
  ds_write_b32 v15, v8
  s_add_u32 s52, s51, 49152
  s_and_b32 s52, s52, 0xffff
  s_mov_b32 m0, 114688
  s_nop 0
  buffer_load_dwordx4 v24, s[64:67], s52 offen offset:0 nt lds
  buffer_load_dwordx4 v25, s[64:67], s52 offen offset:1024 nt lds
  buffer_load_dwordx4 v24, s[64:67], s52 offen offset:2048 nt lds
  buffer_load_dwordx4 v25, s[64:67], s52 offen offset:3072 nt lds
  s_waitcnt vmcnt(28)
  v_mov_b32 v8, 29
  ds_write_b32 v15, v8
  s_add_u32 s52, s51, 53248
  s_and_b32 s52, s52, 0xffff
  s_mov_b32 m0, 118784
  s_nop 0
  buffer_load_dwordx4 v24, s[64:67], s52 offen offset:0 nt lds
  buffer_load_dwordx4 v25, s[64:67], s52 offen offset:1024 nt lds
  buffer_load_dwordx4 v24, s[64:67], s52 offen offset:2048 nt lds
  buffer_load_dwordx4 v25, s[64:67], s52 offen offset:3072 nt lds
  s_waitcnt vmcnt(28)
  v_mov_b32 v8, 30
  ds_write_b32 v15, v8
  s_add_u32 s52, s51, 57344
  s_and_b32 s52, s52, 0xffff
  s_mov_b32 m0, 122880
  s_nop 0
  buffer_load_dwordx4 v24, s[64:67], s52 offen offset:0 nt lds
  buffer_load_dwordx4 v25, s[64:67], s52 offen offset:1024 nt lds
  buffer_load_dwordx4 v24, s[64:67], s52 offen offset:2048 nt lds
  buffer_load_dwordx4 v25, s[64:67], s52 offen offset:3072 nt lds
  s_waitcnt vmcnt(28)
  v_mov_b32 v8, 31
  ds_write_b32 v15, v8
  s_add_u32 s52, s51, 61440
  s_and_b32 s52, s52, 0xffff
  s_mov_b32 m0, 126976
  s_nop 0
  buffer_load_dwordx4 v24, s[64:67], s52 offen offset:0 nt lds
  buffer_load_dwordx4 v25, s[64:67], s52 offen offset:1024 nt lds
  buffer_load_dwordx4 v24, s[64:67], s52 offen offset:2048 nt lds
  buffer_load_dwordx4 v25, s[64:67], s52 offen offset:3072 nt lds
  s_waitcnt vmcnt(28)
  v_mov_b32 v8, 32
  ds_write_b32 v15, v8
  s_lshl_b32 s45, s38, 7
  s_add_u32 s47, s40, s33
  s_lshl_b32 s47, s47, 16
  s_add_u32 s47, s47, s45
  s_cmp_lt_u32 s33, s41
  s_cselect_b32 s50, 64640, 0
  s_cselect_b32 s47, s47, 0
  s_add_u32 s76, s18, s47
  s_addc_u32 s77, s19, 0
  s_mov_b32 s78, s50
  s_mov_b32 s79, 0x20000
  v_lshl_add_u32 v28, v4, 10, v5
  v_lshl_add_u32 v29, v4, 10, v6
  s_mov_b32 m0, 147456
  s_mov_b32 s52, 0
  s_mov_b32 s53, 8192
  buffer_load_dwordx4 v28, s[76:79], s52 offen nt lds
  s_add_u32 m0, m0, 0x400
  s_add_u32 s52, s52, s53
  buffer_load_dwordx4 v29, s[76:79], s52 offen nt lds
  s_add_u32 m0, m0, 0x400
  s_add_u32 s52, s52, s53
  buffer_load_dwordx4 v28, s[76:79], s52 offen nt lds
  s_add_u32 m0, m0, 0x400
  s_add_u32 s52, s52, s53
  buffer_load_dwordx4 v29, s[76:79], s52 offen nt lds
  s_waitcnt vmcnt(28)
  v_mov_b32 v8, 33
  ds_write_b32 v15, v8
  s_add_u32 m0, m0, 0x400
  s_add_u32 s52, s52, s53
  buffer_load_dwordx4 v28, s[76:79], s52 offen nt lds
  s_add_u32 m0, m0, 0x400
  s_add_u32 s52, s52, s53
  buffer_load_dwordx4 v29, s[76:79], s52 offen nt lds
  s_add_u32 m0, m0, 0x400
  s_add_u32 s52, s52, s53
  buffer_load_dwordx4 v28, s[76:79], s52 offen nt lds
  s_add_u32 m0, m0, 0x400
  s_add_u32 s52, s52, s53
  buffer_load_dwordx4 v29, s[76:79], s52 offen nt lds
  s_waitcnt vmcnt(28)
  v_mov_b32 v8, 34
  ds_write_b32 v15, v8
  s_lshl_b32 s45, s38, 7
  s_lshl_b32 s46, s29, 2
  s_add_u32 s46, s46, s33
  s_lshl_b32 s46, s46, 17
  s_add_u32 s46, s46, s45
  s_add_u32 s72, s12, s46
  s_addc_u32 s73, s13, 0
  s_mov_b32 s74, 130176
  s_mov_b32 s75, 0x20000
  v_lshl_add_u32 v28, v4, 10, v5
  v_lshl_add_u32 v29, v4, 10, v6
  s_mov_b32 m0, 131072
  s_mov_b32 s52, 0
  s_mov_b32 s53, 8192
  buffer_load_dwordx4 v28, s[72:75], s52 offen nt lds
  s_add_u32 m0, m0, 0x400
  s_add_u32 s52, s52, s53
  buffer_load_dwordx4 v29, s[72:75], s52 offen nt lds
  s_add_u32 m0, m0, 0x400
  s_add_u32 s52, s52, s53
  buffer_load_dwordx4 v28, s[72:75], s52 offen nt lds
  s_add_u32 m0, m0, 0x400
  s_add_u32 s52, s52, s53
  buffer_load_dwordx4 v29, s[72:75], s52 offen nt lds
  s_waitcnt vmcnt(28)
  v_mov_b32 v8, 35
  ds_write_b32 v15, v8
  s_add_u32 m0, m0, 0x400
  s_add_u32 s52, s52, s53
  buffer_load_dwordx4 v28, s[72:75], s52 offen nt lds
  s_add_u32 m0, m0, 0x400
  s_add_u32 s52, s52, s53
  buffer_load_dwordx4 v29, s[72:75], s52 offen nt lds
  s_add_u32 m0, m0, 0x400
  s_add_u32 s52, s52, s53
  buffer_load_dwordx4 v28, s[72:75], s52 offen nt lds
  s_add_u32 m0, m0, 0x400
  s_add_u32 s52, s52, s53
  buffer_load_dwordx4 v29, s[72:75], s52 offen nt lds
  s_waitcnt vmcnt(28)
  v_mov_b32 v8, 36
  ds_write_b32 v15, v8
  s_add_u32 m0, m0, 0x400
  s_add_u32 s52, s52, s53
  buffer_load_dwordx4 v28, s[72:75], s52 offen nt lds
  s_add_u32 m0, m0, 0x400
  s_add_u32 s52, s52, s53
  buffer_load_dwordx4 v29, s[72:75], s52 offen nt lds
  s_add_u32 m0, m0, 0x400
  s_add_u32 s52, s52, s53
  buffer_load_dwordx4 v28, s[72:75], s52 offen nt lds
  s_add_u32 m0, m0, 0x400
  s_add_u32 s52, s52, s53
  buffer_load_dwordx4 v29, s[72:75], s52 offen nt lds
  s_waitcnt vmcnt(28)
  v_mov_b32 v8, 37
  ds_write_b32 v15, v8
  s_add_u32 m0, m0, 0x400
  s_add_u32 s52, s52, s53
  buffer_load_dwordx4 v28, s[72:75], s52 offen nt lds
  s_add_u32 m0, m0, 0x400
  s_add_u32 s52, s52, s53
  buffer_load_dwordx4 v29, s[72:75], s52 offen nt lds
  s_add_u32 m0, m0, 0x400
  s_add_u32 s52, s52, s53
  buffer_load_dwordx4 v28, s[72:75], s52 offen nt lds
  s_add_u32 m0, m0, 0x400
  s_add_u32 s52, s52, s53
  buffer_load_dwordx4 v29, s[72:75], s52 offen nt lds
  v_lshrrev_b32 v4, 1, v0
  v_lshlrev_b32 v4, 10, v4
  v_and_b32 v5, 1, v0
  v_lshl_add_u32 v4, v5, 4, v4
  s_lshl_b32 s54, s29, 15
  s_lshl_b32 s55, s31, 9
  s_add_u32 s54, s54, s55
  s_lshl_b32 s55, s32, 5
  s_add_u32 s54, s54, s55
  s_add_u32 s54, s54, 1179648
  v_add_u32 v4, s54, v4
  s_lshl_b32 s54, s31, 10
  s_lshl_b32 s55, s29, 7
  s_add_u32 s54, s54, s55
  s_lshl_b32 s55, s32, 3
  s_add_u32 s54, s54, s55
  v_lshlrev_b32 v5, 2, v5
  v_add_u32 v5, s54, v5
  s_waitcnt vmcnt(28)
  v_mov_b32 v8, 38
  ds_write_b32 v15, v8
  s_waitcnt vmcnt(24)
  v_mov_b32 v8, 39
  ds_write_b32 v15, v8
  s_waitcnt vmcnt(20)
  v_mov_b32 v8, 40
  ds_write_b32 v15, v8
  s_waitcnt vmcnt(16)
  v_mov_b32 v8, 41
  ds_write_b32 v15, v8
  s_waitcnt vmcnt(12)
  v_mov_b32 v8, 42
  ds_write_b32 v15, v8
  s_waitcnt vmcnt(8)
  v_mov_b32 v8, 43
  ds_write_b32 v15, v8
  s_waitcnt vmcnt(4)
  v_mov_b32 v8, 44
  ds_write_b32 v15, v8
  s_waitcnt vmcnt(0)
  v_mov_b32 v8, 45
  ds_write_b32 v15, v8
  s_waitcnt lgkmcnt(0)
  s_add_u32 s35, s35, 1
  v_mov_b32 v7, 161060
  s_mov_b32 s93, 2097152
L_outw_3:
  s_sub_u32 s93, s93, 1
  s_cbranch_scc1 L_outwd_4
  ds_read_b32 v9, v7
  s_waitcnt lgkmcnt(0)
  v_readfirstlane_b32 s53, v9
  s_cmp_ge_u32 s53, 4
  s_cbranch_scc0 L_outw_3
L_outwd_4:
  s_mov_b32 s53, 2097152
L_fin_5:
  global_load_dwordx4 v[16:19], v4, s[26:27] sc1
  s_waitcnt vmcnt(0)
  v_cmp_ne_u32 vcc, s35, v17
  v_cmp_ne_u32 s[56:57], s35, v19
  s_or_b64 exec, vcc, s[56:57]
  s_cbranch_execz L_find_6
  s_sub_u32 s53, s53, 1
  s_cbranch_scc0 L_fin_5
L_find_6:
  s_mov_b64 exec, -1
  v_add_f32_dpp v16, v16, v16 quad_perm:[2,3,0,1] row_mask:0xf bank_mask:0xf
  v_add_f32_dpp v18, v18, v18 quad_perm:[2,3,0,1] row_mask:0xf bank_mask:0xf
  s_nop 0
  v_add_f32_dpp v16, v16, v16 row_ror:4 row_mask:0xf bank_mask:0xf
  v_add_f32_dpp v18, v18, v18 row_ror:4 row_mask:0xf bank_mask:0xf
  s_nop 0
  v_add_f32_dpp v16, v16, v16 row_ror:8 row_mask:0xf bank_mask:0xf
  v_add_f32_dpp v18, v18, v18 row_ror:8 row_mask:0xf bank_mask:0xf
  v_mov_b32 v20, v16
  v_mov_b32 v21, v18
  s_nop 1
  v_permlane16_swap_b32 v16, v20
  v_permlane16_swap_b32 v18, v21
  s_nop 1
  v_add_f32 v16, v16, v20
  v_add_f32 v18, v18, v21
  v_mov_b32 v20, v16
  v_mov_b32 v21, v18
  s_nop 1
  v_permlane32_swap_b32 v16, v20
  v_permlane32_swap_b32 v18, v21
  s_nop 1
  v_add_f32 v16, v16, v20
  v_add_f32 v18, v18, v21
  v_cvt_pk_bf16_f32 v16, v16, v18
  s_mov_b64 exec, 3
  global_store_dword v5, v16, s[22:23]
  s_cmp_lg_u32 s2, 0
  s_cbranch_scc1 L_lfin
  s_mov_b64 exec, 1
  v_mov_b32 v6, 0
  v_mov_b32 v7, s35
  global_store_dword v6, v7, s[26:27] offset:0 sc1
L_lfin:
  s_mov_b64 exec, -1
  s_branch L_fin
L_aux:
  v_lshrrev_b32 v11, 4, v0
  v_and_b32 v12, 15, v0
  v_bfe_u32 v13, v0, 2, 2
  v_and_b32 v14, 3, v0
  v_mov_b32 v15, 160768
  s_mov_b32 s39, 0
  v_lshl_add_u32 v1, v11, 3, v13
  v_lshlrev_b32 v1, 7, v1
  v_lshl_add_u32 v1, v14, 3, v1
  v_lshrrev_b32 v2, 1, v13
  v_and_b32 v3, 1, v11
  v_lshl_or_b32 v2, v3, 1, v2
  v_lshl_add_u32 v3, v2, 5, v1
  v_add_u32 v16, 147456, v3
  v_xor_b32 v17, 32, v16
  v_xor_b32 v18, 64, v16
  v_xor_b32 v19, 96, v16
  s_lshl_b32 s42, s29, 14
  s_lshl_b32 s43, s33, 12
  s_add_u32 s42, s42, s43
  s_add_u32 s42, s42, 917504
  v_lshlrev_b32 v31, 4, v0
  v_add_u32 v31, s42, v31
  s_waitcnt lgkmcnt(0)
  v_mov_b32 v4, 0
  v_mov_b32 v5, 0
  s_cmp_lt_u32 s33, s41
  s_cbranch_scc0 L_ffn_store
  v_mov_b32 v8, 161068
  s_mov_b32 s63, 2097152
L_wf_7:
  s_sub_u32 s63, s63, 1
  s_cbranch_scc1 L_wfd_8
  ds_read_b32 v9, v8
  s_waitcnt lgkmcnt(0)
  v_readfirstlane_b32 s45, v9
  s_cmp_ge_u32 s45, 1
  s_cbranch_scc0 L_wf_7
L_wfd_8:
  s_and_b32 s45, s45, 2
  s_lshl_b32 s45, s45, 20
  v_add_u32 v31, s45, v31
  s_mov_b32 s44, 2097152
L_hpoll_9:
  s_cmp_lg_u32 s45, 0
  s_cbranch_scc1 L_gfar_11
  global_load_dwordx4 v[208:211], v31, s[26:27] offset:0 nt
  global_load_dwordx4 v[212:215], v31, s[26:27] offset:1024 nt
  global_load_dwordx4 v[216:219], v31, s[26:27] offset:2048 nt
  global_load_dwordx4 v[220:223], v31, s[26:27] offset:3072 nt
  s_branch L_gdone_12
L_gfar_11:
  global_load_dwordx4 v[208:211], v31, s[26:27] offset:0 sc1
  global_load_dwordx4 v[212:215], v31, s[26:27] offset:1024 sc1
  global_load_dwordx4 v[216:219], v31, s[26:27] offset:2048 sc1
  global_load_dwordx4 v[220:223], v31, s[26:27] offset:3072 sc1
L_gdone_12:
  s_waitcnt vmcnt(0)
  v_max3_u32 v1, v208, v209, v210
  v_max3_u32 v1, v1, v211, v212
  v_max3_u32 v1, v1, v213, v214
  v_max3_u32 v1, v1, v215, v216
  v_max3_u32 v1, v1, v217, v218
  v_max3_u32 v1, v1, v219, v220
  v_max3_u32 v1, v1, v221, v222
  v_max_u32 v1, v1, v223
  v_cmp_eq_u32 vcc, -1, v1
  s_and_b64 exec, exec, vcc
  s_cbranch_execz L_hdone_10
  s_sub_u32 s44, s44, 1
  s_cbranch_scc0 L_hpoll_9
L_hdone_10:
  s_mov_b64 exec, -1
  v_add_f32 v208, v208, v212
  v_add_f32 v216, v216, v220
  v_add_f32 v209, v209, v213
  v_add_f32 v217, v217, v221
  v_add_f32 v210, v210, v214
  v_add_f32 v218, v218, v222
  v_add_f32 v211, v211, v215
  v_add_f32 v219, v219, v223
  v_add_f32 v208, v208, v216
  v_add_f32 v209, v209, v217
  v_add_f32 v210, v210, v218
  v_add_f32 v211, v211, v219
  v_mov_b32 v212, v208
  v_mov_b32 v213, v209
  v_mov_b32 v214, v210
  v_mov_b32 v215, v211
  s_nop 1
  v_permlane32_swap_b32 v208, v212
  v_permlane32_swap_b32 v209, v213
  v_permlane32_swap_b32 v210, v214
  v_permlane32_swap_b32 v211, v215
  s_nop 1
  s_mov_b32 s42, 1069066811
  v_add_f32 v208, v208, v212
  v_add_f32 v209, v209, v213
  v_add_f32 v210, v210, v214
  v_add_f32 v211, v211, v215
  v_mul_f32 v212, s42, v208
  v_mul_f32 v213, s42, v209
  v_mul_f32 v214, s42, v210
  v_mul_f32 v215, s42, v211
  v_sub_f32 v212, 0, v212
  v_sub_f32 v213, 0, v213
  v_sub_f32 v214, 0, v214
  v_sub_f32 v215, 0, v215
  v_exp_f32 v212, v212
  v_exp_f32 v213, v213
  v_exp_f32 v214, v214
  v_exp_f32 v215, v215
  s_nop 0
  v_add_f32 v212, 1.0, v212
  v_add_f32 v213, 1.0, v213
  v_add_f32 v214, 1.0, v214
  v_add_f32 v215, 1.0, v215
  v_rcp_f32 v212, v212
  v_rcp_f32 v213, v213
  v_rcp_f32 v214, v214
  v_rcp_f32 v215, v215
  s_nop 0
  v_mul_f32 v208, v208, v212
  v_mul_f32 v209, v209, v213
  v_mul_f32 v210, v210, v214
  v_mul_f32 v211, v211, v215
  v_cvt_pk_bf16_f32 v4, v208, v209
  v_cvt_pk_bf16_f32 v5, v210, v211
  v_and_b32 v1, 31, v0
  v_lshlrev_b32 v1, 3, v1
  v_add_u32 v1, 159744, v1
  ds_write_b64 v1, v[4:5]
  v_and_b32 v1, 1, v12
  v_lshlrev_b32 v1, 7, v1
  v_lshl_add_u32 v1, v11, 4, v1
  v_add_u32 v1, 159744, v1
  s_waitcnt lgkmcnt(0)
  ds_read_b128 v[56:59], v1
  ds_read_b128 v[60:63], v1 offset:64
  s_cmp_ge_u32 s39, 41
  s_cbranch_scc1 L_wpd_14
  s_mov_b32 s63, 2097152
L_wp_13:
  ds_read_b32 v9, v15
  s_sub_u32 s63, s63, 1
  s_cbranch_scc1 L_wpd_14
  s_waitcnt lgkmcnt(0)
  v_readfirstlane_b32 s39, v9
  s_cmp_ge_u32 s39, 41
  s_cbranch_scc0 L_wp_13
L_wpd_14:
  ds_read_b64_tr_b16 v[208:209], v16 offset:0
  ds_read_b64_tr_b16 v[210:211], v16 offset:512
  ds_read_b64_tr_b16 v[212:213], v16 offset:4096
  ds_read_b64_tr_b16 v[214:215], v16 offset:4608
  ds_read_b64_tr_b16 v[216:217], v17 offset:0
  ds_read_b64_tr_b16 v[218:219], v17 offset:512
  ds_read_b64_tr_b16 v[220:221], v17 offset:4096
  ds_read_b64_tr_b16 v[222:223], v17 offset:4608
  ds_read_b64_tr_b16 v[224:225], v18 offset:0
  ds_read_b64_tr_b16 v[226:227], v18 offset:512
  ds_read_b64_tr_b16 v[228:229], v18 offset:4096
  ds_read_b64_tr_b16 v[230:231], v18 offset:4608
  s_waitcnt lgkmcnt(4)
  ds_read_b64_tr_b16 v[232:233], v19 offset:0
  ds_read_b64_tr_b16 v[234:235], v19 offset:512
  ds_read_b64_tr_b16 v[236:237], v19 offset:4096
  ds_read_b64_tr_b16 v[238:239], v19 offset:4608
  s_waitcnt lgkmcnt(0)
  v_mfma_f32_16x16x32_bf16 v[96:99], v[56:59], v[208:211], 0
  v_mfma_f32_16x16x32_bf16 v[100:103], v[56:59], v[216:219], 0
  v_mfma_f32_16x16x32_bf16 v[104:107], v[56:59], v[224:227], 0
  v_mfma_f32_16x16x32_bf16 v[108:111], v[56:59], v[232:235], 0
  v_mfma_f32_16x16x32_bf16 v[96:99], v[60:63], v[212:215], v[96:99]
  v_mfma_f32_16x16x32_bf16 v[100:103], v[60:63], v[220:223], v[100:103]
  v_mfma_f32_16x16x32_bf16 v[104:107], v[60:63], v[228:231], v[104:107]
  v_mfma_f32_16x16x32_bf16 v[108:111], v[60:63], v[236:239], v[108:111]
  v_cmp_eq_u32 vcc, 1, v11
  v_cmp_eq_u32 s[44:45], 2, v11
  v_cmp_eq_u32 s[56:57], 3, v11
  s_nop 6
  v_cndmask_b32 v4, v96, v100, vcc
  v_cndmask_b32 v4, v4, v104, s[44:45]
  v_cndmask_b32 v4, v4, v108, s[56:57]
  v_cndmask_b32 v5, v97, v101, vcc
  v_cndmask_b32 v5, v5, v105, s[44:45]
  v_cndmask_b32 v5, v5, v109, s[56:57]
L_ffn_store:
  v_lshlrev_b32 v1, 2, v0
  v_add_u32 v1, 160000, v1
  ds_write_b32 v1, v4
  ds_write_b32 v1, v5 offset:256
  v_mov_b32 v2, 161064
  v_mov_b32 v3, 1
  s_waitcnt lgkmcnt(0)
  s_mov_b64 exec, 1
  ds_write_b32 v2, v3
  s_mov_b64 exec, -1
  s_branch L_fin
L_main:
  s_getpc_b64 s[42:43]
L_pc:
  s_sub_u32 s42, s42, L_pc-gated_mix__sliding_block_cached__dense_activation_silu__decode_kernel
  s_subb_u32 s43, s43, 0
  s_lshl_b32 s44, s30, 10
  v_lshlrev_b32 v1, 4, v0
  v_add_u32 v1, s44, v1
  v_min_u32 v1, L_end-gated_mix__sliding_block_cached__dense_activation_silu__decode_kernel-16, v1
  s_cmp_lg_u32 s28, 3
  s_cbranch_scc1 L_nopf
  global_load_dwordx4 v[252:255], v1, s[42:43]
L_nopf:
  v_lshrrev_b32 v11, 4, v0
  v_and_b32 v12, 15, v0
  v_bfe_u32 v13, v0, 2, 2
  v_and_b32 v14, 3, v0
  v_mov_b32 v15, 160768
  s_mov_b32 s39, 0
  s_getreg_b32 s36, hwreg(HW_REG_XCC_ID, 0, 4)
  s_lshr_b32 s58, s28, 1
  s_and_b32 s59, s28, 1
  s_lshl_b32 s42, s29, 15
  s_lshl_b32 s43, s31, 14
  s_add_u32 s42, s42, s43
  s_lshl_b32 s43, s32, 4
  s_add_u32 s42, s42, s43
  s_add_u32 s60, s42, 589824
  s_lshl_b32 s42, s29, 14
  s_lshl_b32 s43, s3, 12
  s_add_u32 s42, s42, s43
  s_lshr_b32 s43, s30, 2
  s_lshl_b32 s43, s43, 9
  s_add_u32 s42, s42, s43
  s_add_u32 s61, s42, 917504
  s_lshl_b32 s42, s29, 10
  s_lshl_b32 s43, s28, 8
  s_add_u32 s42, s42, s43
  s_lshl_b32 s43, s30, 3
  s_add_u32 s42, s42, s43
  s_add_u32 s62, s42, 851968
  s_lshl_b32 s43, s28, 12
  s_add_u32 s43, s43, s60
  v_lshlrev_b32 v1, 8, v0
  v_add_u32 v1, s43, v1
  s_lshl_b32 s43, s28, 6
  s_add_u32 s43, s43, s61
  v_bfe_u32 v2, v0, 2, 1
  v_lshlrev_b32 v2, 8, v2
  v_lshl_add_u32 v2, v14, 4, v2
  v_add_u32 v2, s43, v2
  v_cmp_gt_u32 vcc, 16, v0
  v_mov_b32 v234, s62
  v_mov_b32 v4, -1
  v_cndmask_b32 v233, v2, v1, vcc
  v_mov_b32 v5, -1
  v_mov_b32 v6, -1
  v_mov_b32 v7, -1
  s_waitcnt lgkmcnt(0)
  s_load_dword s35, s[26:27], 0
  s_mov_b64 exec, 0xffffff
  global_store_dwordx4 v233, v[4:7], s[26:27]
  s_mov_b64 exec, 1
  global_store_dwordx2 v234, v[4:5], s[26:27]
  s_mov_b64 exec, -1
  v_lshl_add_u32 v1, v11, 3, v13
  v_lshlrev_b32 v1, 7, v1
  v_lshl_add_u32 v1, v14, 3, v1
  v_lshrrev_b32 v2, 1, v13
  v_and_b32 v3, 1, v11
  v_lshl_or_b32 v2, v3, 1, v2
  v_xor_b32 v3, s28, v2
  v_lshl_add_u32 v3, v3, 5, v1
  v_add_u32 v16, 114688, v3
  v_add_u32 v17, 106496, v3
  s_lshl_b32 s42, s59, 1
  v_xor_b32 v3, s42, v2
  v_lshl_add_u32 v3, v3, 5, v1
  v_add_u32 v18, 131072, v3
  v_xor_b32 v19, 32, v18
  v_and_b32 v1, 1, v12
  v_lshlrev_b32 v1, 10, v1
  v_lshl_add_u32 v1, v11, 4, v1
  v_add_u32 v1, 155648, v1
  s_lshl_b32 s42, s33, 8
  v_add_u32 v20, s42, v1
  s_lshr_b32 s42, s30, 2
  s_lshl_b32 s42, s42, 7
  v_add_u32 v21, s42, v1
  v_xor_b32 v1, v11, v12
  s_lshl_b32 s42, s28, 14
  v_lshlrev_b32 v2, 8, v12
  v_add_u32 v2, s42, v2
  v_xor_b32 v3, 0, v1
  v_lshl_add_u32 v22, v3, 4, v2
  v_xor_b32 v3, 4, v1
  v_lshl_add_u32 v23, v3, 4, v2
  v_xor_b32 v3, 8, v1
  v_lshl_add_u32 v24, v3, 4, v2
  v_xor_b32 v3, 12, v1
  v_lshl_add_u32 v25, v3, 4, v2
  v_lshl_add_u32 v1, v11, 2, v13
  v_and_b32 v2, 7, v1
  v_lshlrev_b32 v1, 8, v1
  v_lshl_add_u32 v1, v14, 3, v1
  v_add_u32 v1, 65536, v1
  s_lshl_b32 s42, s28, 1
  v_xor_b32 v2, s42, v2
  v_lshl_add_u32 v26, v2, 5, v1
  v_xor_b32 v27, 32, v26
  s_lshl_b32 s42, s29, 16
  s_lshl_b32 s43, s33, 11
  s_add_u32 s42, s42, s43
  s_lshl_b32 s43, s34, 8
  s_add_u32 s42, s42, s43
  s_lshl_b32 s43, s28, 6
  s_add_u32 s42, s42, s43
  s_add_u32 s42, s42, 65536
  v_lshlrev_b32 v1, 15, v12
  v_lshl_add_u32 v1, v11, 4, v1
  v_add_u32 v232, s42, v1
  s_lshl_b32 s42, s28, 6
  s_add_u32 s42, s42, s61
  v_lshlrev_b32 v1, 8, v12
  v_lshl_add_u32 v1, v11, 4, v1
  v_add_u32 v235, s42, v1
  s_lshl_b32 s42, s29, 16
  s_lshl_b32 s43, s31, 15
  s_add_u32 s42, s42, s43
  s_lshl_b32 s43, s28, 9
  s_add_u32 s42, s42, s43
  s_add_u32 s42, s42, 65536
  v_lshrrev_b32 v1, 5, v0
  v_lshlrev_b32 v1, 11, v1
  v_and_b32 v2, 31, v0
  v_lshl_add_u32 v1, v2, 4, v1
  v_add_u32 v30, s42, v1
  v_cmp_gt_u32 s[46:47], 8, v12
  v_cmp_gt_u32 s[48:49], 2, v12
  s_cmp_ge_u32 s39, 1
  s_cbranch_scc1 L_wpd_16
  s_mov_b32 s63, 2097152
L_wp_15:
  ds_read_b32 v9, v15
  s_sub_u32 s63, s63, 1
  s_cbranch_scc1 L_wpd_16
  s_waitcnt lgkmcnt(0)
  v_readfirstlane_b32 s39, v9
  s_cmp_ge_u32 s39, 1
  s_cbranch_scc0 L_wp_15
L_wpd_16:
  v_lshlrev_b32 v1, 4, v0
  s_lshl_b32 s42, s58, 10
  s_add_u32 s42, s42, 155648
  v_add_u32 v2, s42, v1
  v_add_u32 v1, 157696, v1
  ds_read_b128 v[32:35], v2
  ds_read_b128 v[36:39], v1
  ds_read_b128 v[40:43], v20 offset:0
  ds_read_b128 v[44:47], v20 offset:64
  ds_read_b128 v[48:51], v20 offset:128
  ds_read_b128 v[52:55], v20 offset:192
  ds_read_b128 v[56:59], v21 offset:0
  ds_read_b128 v[60:63], v21 offset:64
  v_mov_b32 v28, 0
  s_waitcnt lgkmcnt(6)
  v_dot2c_f32_bf16 v28, v32, v36
  v_dot2c_f32_bf16 v28, v33, v37
  v_dot2c_f32_bf16 v28, v34, v38
  v_dot2c_f32_bf16 v28, v35, v39
  s_nop 2
  v_add_f32_dpp v28, v28, v28 quad_perm:[1,0,3,2] row_mask:0xf bank_mask:0xf
  s_nop 1
  v_add_f32_dpp v28, v28, v28 quad_perm:[2,3,0,1] row_mask:0xf bank_mask:0xf
  s_nop 1
  v_add_f32_dpp v28, v28, v28 row_ror:4 row_mask:0xf bank_mask:0xf
  s_nop 1
  v_add_f32_dpp v28, v28, v28 row_ror:8 row_mask:0xf bank_mask:0xf
  v_mov_b32 v1, v28
  s_nop 1
  v_permlane16_swap_b32 v28, v1
  s_nop 1
  v_add_f32 v28, v28, v1
  v_mov_b32 v1, v28
  s_nop 1
  v_permlane32_swap_b32 v28, v1
  s_nop 1
  v_add_f32 v28, v28, v1
  s_mov_b32 s42, 1069066811
  v_mul_f32 v28, s42, v28
  v_sub_f32 v28, 0, v28
  v_exp_f32 v28, v28
  s_nop 0
  v_add_f32 v28, 1.0, v28
  v_rcp_f32 v28, v28
  s_nop 0
  v_sub_f32 v29, 1.0, v28
  s_cmp_ge_u32 s39, 5
  s_cbranch_scc1 L_wpd_18
  s_mov_b32 s63, 2097152
L_wp_17:
  ds_read_b32 v9, v15
  s_sub_u32 s63, s63, 1
  s_cbranch_scc1 L_wpd_18
  s_waitcnt lgkmcnt(0)
  v_readfirstlane_b32 s39, v9
  s_cmp_ge_u32 s39, 5
  s_cbranch_scc0 L_wp_17
L_wpd_18:
  ds_read_b64_tr_b16 v[64:65], v16 offset:0
  ds_read_b64_tr_b16 v[66:67], v16 offset:512
  ds_read_b64_tr_b16 v[68:69], v16 offset:4096
  ds_read_b64_tr_b16 v[70:71], v16 offset:4608
  ds_read_b64_tr_b16 v[72:73], v16 offset:8192
  ds_read_b64_tr_b16 v[74:75], v16 offset:8704
  ds_read_b64_tr_b16 v[76:77], v16 offset:12288
  ds_read_b64_tr_b16 v[78:79], v16 offset:12800
  s_waitcnt lgkmcnt(6)
  v_mfma_f32_16x16x32_bf16 v[80:83], v[64:67], v[40:43], 0
  s_waitcnt lgkmcnt(4)
  v_mfma_f32_16x16x32_bf16 v[80:83], v[68:71], v[44:47], v[80:83]
  s_waitcnt lgkmcnt(2)
  v_mfma_f32_16x16x32_bf16 v[80:83], v[72:75], v[48:51], v[80:83]
  s_waitcnt lgkmcnt(0)
  v_mfma_f32_16x16x32_bf16 v[80:83], v[76:79], v[52:55], v[80:83]
  s_waitcnt lgkmcnt(0)
  s_add_u32 s35, s35, 1
  s_lshl_b32 s43, s36, 24
  s_xor_b32 s43, s43, s35
  v_mov_b32 v229, s35
  v_mov_b32 v231, s43
  s_mov_b32 s40, 0
  s_waitcnt vmcnt(0)
  s_nop 1
  v_cvt_pk_bf16_f32 v228, v80, v81
  v_cvt_pk_bf16_f32 v230, v82, v83
  s_mov_b64 exec, s[48:49]
  global_store_dwordx4 v232, v[228:231], s[26:27]
  s_mov_b64 exec, -1
  s_cmp_ge_u32 s39, 7
  s_cbranch_scc1 L_wpd_20
  s_mov_b32 s63, 2097152
L_wp_19:
  ds_read_b32 v9, v15
  s_sub_u32 s63, s63, 1
  s_cbranch_scc1 L_wpd_20
  s_waitcnt lgkmcnt(0)
  v_readfirstlane_b32 s39, v9
  s_cmp_ge_u32 s39, 7
  s_cbranch_scc0 L_wp_19
L_wpd_20:
  ds_read_b64_tr_b16 v[64:65], v17 offset:0
  ds_read_b64_tr_b16 v[66:67], v17 offset:512
  ds_read_b64_tr_b16 v[68:69], v17 offset:4096
  ds_read_b64_tr_b16 v[70:71], v17 offset:4608
  s_waitcnt lgkmcnt(2)
  v_mfma_f32_16x16x32_bf16 v[224:227], v[64:67], v[56:59], 0
  s_waitcnt lgkmcnt(0)
  v_mfma_f32_16x16x32_bf16 v[224:227], v[68:71], v[60:63], v[224:227]
  v_mov_b32 v1, 161056
  v_mov_b32 v2, 1
  s_mov_b64 exec, 1
  ds_add_u32 v1, v2
  s_mov_b64 exec, -1
  s_cmp_lt_u32 s3, s41
  s_cselect_b64 s[50:51], s[48:49], 0
  s_nop 3
  s_cmp_eq_u64 s[50:51], 0
  s_cbranch_scc1 L_nohpub
  s_mov_b64 exec, s[50:51]
  global_store_dwordx4 v235, v[224:227], s[26:27]
  s_mov_b64 exec, -1
L_nohpub:
  s_mov_b32 s44, 0
L_qpoll_21:
  s_cmp_lt_u32 s44, 2
  s_cselect_b32 s45, 0, s44
  s_and_b32 s45, s45, 1
  s_mul_i32 s45, s45, 2097152
  v_add_u32 v1, s45, v30
  s_cmp_lg_u32 s45, 0
  s_cbranch_scc1 L_gfar_25
  global_load_dwordx4 v[144:147], v1, s[26:27] nt
  v_add_u32 v1, 0x1000, v1
  global_load_dwordx4 v[148:151], v1, s[26:27] nt
  s_branch L_gdone_26
L_gfar_25:
  global_load_dwordx4 v[144:147], v1, s[26:27] sc1
  v_add_u32 v1, 0x1000, v1
  global_load_dwordx4 v[148:151], v1, s[26:27] sc1
L_gdone_26:
  s_cmp_eq_u32 s44, 2
  s_cbranch_scc0 L_qnob_23
  s_mov_b64 s[56:57], exec
  s_mov_b64 exec, s[48:49]
  v_add_u32 v3, 2097152, v232
  global_store_dwordx4 v3, v[228:231], s[26:27] sc1
  s_mov_b64 exec, s[56:57]
  s_mov_b32 s40, 1
L_qnob_23:
  s_waitcnt vmcnt(0)
  v_xor_b32 v145, s35, v145
  v_xor_b32 v147, s35, v147
  v_xor_b32 v149, s35, v149
  v_xor_b32 v151, s35, v151
  v_or_b32 v3, v147, v151
  v_or_b32 v4, v145, v149
  v_and_b32 v3, 0xf0ffffff, v3
  v_or_b32 v3, v3, v4
  v_cmp_ne_u32 vcc, 0, v3
  s_and_b64 exec, exec, vcc
  s_cbranch_execz L_qdone_22
  s_add_u32 s44, s44, 1
  s_cmp_lt_u32 s44, 2097152
  s_cbranch_scc1 L_qpoll_21
L_qdone_22:
  s_mov_b64 exec, -1
  s_lshl_b32 s43, s36, 24
  v_xor_b32 v3, s43, v147
  v_xor_b32 v4, s43, v151
  v_or_b32 v3, v3, v4
  v_cmp_ne_u32 vcc, 0, v3
  v_lshlrev_b32 v40, 16, v144
  v_and_b32 v41, 0xffff0000, v144
  v_lshlrev_b32 v42, 16, v146
  v_and_b32 v43, 0xffff0000, v146
  v_lshlrev_b32 v44, 16, v148
  v_and_b32 v45, 0xffff0000, v148
  v_lshlrev_b32 v46, 16, v150
  v_and_b32 v47, 0xffff0000, v150
  v_add_f32 v40, v40, v44
  v_add_f32 v41, v41, v45
  v_add_f32 v42, v42, v46
  v_add_f32 v43, v43, v47
  s_cmp_eq_u64 vcc, 0
  s_cselect_b32 s45, 3, 1
  s_cselect_b32 s42, 1, s40
  s_cmp_eq_u32 s42, 1
  s_cbranch_scc1 L_qnob2_24
  s_mov_b64 exec, s[48:49]
  v_add_u32 v3, 2097152, v232
  global_store_dwordx4 v3, v[228:231], s[26:27] sc1
  s_mov_b64 exec, -1
  s_mov_b32 s40, 1
L_qnob2_24:
  v_mov_b32 v44, v40
  v_mov_b32 v45, v41
  v_mov_b32 v46, v42
  v_mov_b32 v47, v43
  s_nop 1
  v_permlane32_swap_b32 v40, v44
  v_permlane32_swap_b32 v41, v45
  v_permlane32_swap_b32 v42, v46
  v_permlane32_swap_b32 v43, v47
  s_nop 1
  v_add_f32 v40, v40, v44
  v_add_f32 v41, v41, v45
  v_add_f32 v42, v42, v46
  v_add_f32 v43, v43, v47
  v_cvt_pk_bf16_f32 v4, v40, v41
  v_cvt_pk_bf16_f32 v5, v42, v43
  v_and_b32 v2, 31, v0
  v_lshlrev_b32 v2, 3, v2
  s_lshl_b32 s42, s28, 8
  s_add_u32 s42, s42, 158720
  v_add_u32 v2, s42, v2
  ds_write_b64 v2, v[4:5]
  s_lshl_b32 s42, s28, 2
  s_add_u32 s42, s42, 161024
  v_mov_b32 v1, s42
  v_mov_b32 v2, s45
  s_waitcnt lgkmcnt(0)
  s_mov_b64 exec, 1
  ds_write_b32 v1, v2
  s_mov_b64 exec, -1
  v_mov_b32 v1, 161024
  s_mov_b32 s45, 1
  s_mov_b32 s63, 2097152
L_qrdy_27:
  s_sub_u32 s63, s63, 1
  s_cbranch_scc1 L_qrdyd_28
  s_cmp_eq_u32 s63, 2097088
  s_cbranch_scc0 L_qnob3_29
  s_cmp_eq_u32 s40, 1
  s_cbranch_scc1 L_qnob3_29
  s_mov_b64 exec, s[48:49]
  v_add_u32 v3, 2097152, v232
  global_store_dwordx4 v3, v[228:231], s[26:27] sc1
  s_mov_b64 exec, -1
  s_mov_b32 s40, 1
L_qnob3_29:
  ds_read_b128 v[4:7], v1
  s_waitcnt lgkmcnt(0)
  v_and_b32 v4, v4, v5
  v_and_b32 v6, v6, v7
  v_and_b32 v4, v4, v6
  s_nop 0
  v_readfirstlane_b32 s45, v4
  s_bitcmp1_b32 s45, 0
  s_cbranch_scc0 L_qrdy_27
L_qrdyd_28:
  s_mov_b32 s37, 0
  s_bitcmp1_b32 s45, 1
  s_cbranch_scc1 L_local
  s_mov_b32 s37, 2097152
  s_cmp_eq_u32 s40, 1
  s_cbranch_scc1 L_qb_done
  v_add_u32 v3, 2097152, v232
  s_mov_b64 exec, s[48:49]
  global_store_dwordx4 v3, v[228:231], s[26:27] sc1
  s_mov_b64 exec, -1
L_qb_done:
  v_mov_b32 v4, -1
  v_mov_b32 v5, -1
  v_mov_b32 v6, -1
  v_mov_b32 v7, -1
  v_add_u32 v1, 2097152, v233
  v_add_u32 v2, 2097152, v234
  s_mov_b64 exec, 0xffffff
  global_store_dwordx4 v1, v[4:7], s[26:27] sc1
  s_mov_b64 exec, 1
  global_store_dwordx2 v2, v[4:5], s[26:27] sc1
  s_waitcnt vmcnt(0)
  s_lshl_b32 s42, s29, 9
  s_add_u32 s42, s42, 3244032
  s_lshl_b32 s43, s30, 4
  s_add_u32 s43, s43, s42
  s_lshl_b32 s44, s28, 2
  s_add_u32 s43, s43, s44
  v_mov_b32 v1, s43
  v_mov_b32 v2, s35
  global_store_dword v1, v2, s[26:27] sc1
  s_mov_b64 exec, -1
  v_lshlrev_b32 v1, 3, v0
  v_add_u32 v1, s42, v1
  s_mov_b32 s63, 2097152
L_fb_30:
  s_sub_u32 s63, s63, 1
  s_cbranch_scc1 L_fbd_31
  global_load_dwordx2 v[2:3], v1, s[26:27] sc1
  s_waitcnt vmcnt(0)
  v_cmp_ne_u32 vcc, s35, v2
  v_cmp_ne_u32 s[56:57], s35, v3
  s_or_b64 vcc, vcc, s[56:57]
  s_cbranch_vccnz L_fb_30
L_fbd_31:
  s_cmp_eq_u64 s[50:51], 0
  s_cbranch_scc1 L_local
  v_add_u32 v1, 2097152, v235
  s_mov_b64 exec, s[50:51]
  global_store_dwordx4 v1, v[224:227], s[26:27] sc1
  s_mov_b64 exec, -1
L_local:
  s_cmp_lg_u32 s28, 0
  s_cbranch_scc1 L_nomode
  v_mov_b32 v1, 161068
  s_lshr_b32 s42, s37, 20
  s_add_u32 s42, s42, 1
  v_mov_b32 v2, s42
  s_mov_b64 exec, 1
  ds_write_b32 v1, v2
  s_mov_b64 exec, -1
L_nomode:
  v_lshlrev_b32 v1, 8, v14
  v_lshl_add_u32 v1, v11, 4, v1
  v_add_u32 v1, 158720, v1
  ds_read_b128 v[32:35], v1 offset:0
  ds_read_b128 v[36:39], v1 offset:64
  ds_read_b128 v[40:43], v1 offset:128
  ds_read_b128 v[44:47], v1 offset:192
  s_cmp_ge_u32 s39, 23
  s_cbranch_scc1 L_wpd_33
  s_mov_b32 s63, 2097152
L_wp_32:
  ds_read_b32 v9, v15
  s_sub_u32 s63, s63, 1
  s_cbranch_scc1 L_wpd_33
  s_waitcnt lgkmcnt(0)
  v_readfirstlane_b32 s39, v9
  s_cmp_ge_u32 s39, 23
  s_cbranch_scc0 L_wp_32
L_wpd_33:
  s_waitcnt lgkmcnt(0)
  ds_read_b128 v[64:67], v22 offset:0
  ds_read_b128 v[68:71], v23 offset:0
  ds_read_b128 v[72:75], v24 offset:0
  ds_read_b128 v[76:79], v25 offset:0
  ds_read_b128 v[80:83], v22 offset:4096
  ds_read_b128 v[84:87], v23 offset:4096
  ds_read_b128 v[88:91], v24 offset:4096
  ds_read_b128 v[92:95], v25 offset:4096
  ds_read_b128 v[96:99], v22 offset:8192
  ds_read_b128 v[100:103], v23 offset:8192
  ds_read_b128 v[104:107], v24 offset:8192
  ds_read_b128 v[108:111], v25 offset:8192
  s_waitcnt lgkmcnt(8)
  v_mfma_f32_16x16x32_bf16 v[48:51], v[64:67], v[32:35], 0
  v_mfma_f32_16x16x32_bf16 v[48:51], v[68:71], v[36:39], v[48:51]
  v_mfma_f32_16x16x32_bf16 v[48:51], v[72:75], v[40:43], v[48:51]
  v_mfma_f32_16x16x32_bf16 v[48:51], v[76:79], v[44:47], v[48:51]
  ds_read_b128 v[112:115], v22 offset:12288
  ds_read_b128 v[116:119], v23 offset:12288
  ds_read_b128 v[120:123], v24 offset:12288
  ds_read_b128 v[124:127], v25 offset:12288
  s_waitcnt lgkmcnt(8)
  v_mfma_f32_16x16x32_bf16 v[52:55], v[80:83], v[32:35], 0
  v_mfma_f32_16x16x32_bf16 v[52:55], v[84:87], v[36:39], v[52:55]
  v_mfma_f32_16x16x32_bf16 v[52:55], v[88:91], v[40:43], v[52:55]
  v_mfma_f32_16x16x32_bf16 v[52:55], v[92:95], v[44:47], v[52:55]
  s_waitcnt lgkmcnt(4)
  v_mfma_f32_16x16x32_bf16 v[56:59], v[96:99], v[32:35], 0
  v_mfma_f32_16x16x32_bf16 v[56:59], v[100:103], v[36:39], v[56:59]
  v_mfma_f32_16x16x32_bf16 v[56:59], v[104:107], v[40:43], v[56:59]
  v_mfma_f32_16x16x32_bf16 v[56:59], v[108:111], v[44:47], v[56:59]
  s_waitcnt lgkmcnt(0)
  v_mfma_f32_16x16x32_bf16 v[60:63], v[112:115], v[32:35], 0
  v_mfma_f32_16x16x32_bf16 v[60:63], v[116:119], v[36:39], v[60:63]
  v_mfma_f32_16x16x32_bf16 v[60:63], v[120:123], v[40:43], v[60:63]
  v_mfma_f32_16x16x32_bf16 v[60:63], v[124:127], v[44:47], v[60:63]
  s_lshl_b32 s42, s28, 2
  s_add_u32 s42, s42, 161088
  v_lshlrev_b32 v2, 4, v14
  v_add_u32 v3, s42, v2
  v_add_u32 v2, 161088, v2
  v_max3_f32 v1, v48, v49, v50
  v_max3_f32 v4, v51, v52, v53
  v_max3_f32 v5, v54, v55, v56
  v_max3_f32 v1, v1, v57, v58
  s_nop 2
  v_max3_f32 v4, v4, v59, v60
  v_max3_f32 v5, v5, v61, v62
  v_max3_f32 v1, v1, v4, v5
  v_max_f32 v1, v1, v63
  v_mov_b32 v4, v1
  s_nop 1
  v_permlane16_swap_b32 v1, v4
  s_nop 1
  v_max_f32 v1, v1, v4
  v_mov_b32 v4, v1
  s_nop 1
  v_permlane32_swap_b32 v1, v4
  s_nop 1
  v_max_f32 v1, v1, v4
  s_mov_b64 exec, 15
  ds_write_b32 v3, v1
  s_mov_b64 exec, -1
  s_mov_b32 s63, 2097152
L_mx_34:
  s_sub_u32 s63, s63, 1
  s_cbranch_scc1 L_mxd_35
  ds_read_b128 v[4:7], v2
  s_waitcnt lgkmcnt(0)
  v_max_u32 v8, v4, v5
  v_max3_u32 v8, v8, v6, v7
  v_cmp_eq_u32 vcc, -1, v8
  s_cbranch_vccnz L_mx_34
L_mxd_35:
  v_max3_f32 v1, v4, v5, v6
  v_max_f32 v1, v1, v7
  s_mov_b32 s42, 1040356334
  v_mul_f32 v30, s42, v1
  v_fma_f32 v48, v48, s42, -v30
  v_fma_f32 v49, v49, s42, -v30
  v_fma_f32 v50, v50, s42, -v30
  v_fma_f32 v51, v51, s42, -v30
  v_fma_f32 v52, v52, s42, -v30
  v_fma_f32 v53, v53, s42, -v30
  v_fma_f32 v54, v54, s42, -v30
  v_fma_f32 v55, v55, s42, -v30
  v_fma_f32 v56, v56, s42, -v30
  v_fma_f32 v57, v57, s42, -v30
  v_fma_f32 v58, v58, s42, -v30
  v_fma_f32 v59, v59, s42, -v30
  v_fma_f32 v60, v60, s42, -v30
  v_fma_f32 v61, v61, s42, -v30
  v_fma_f32 v62, v62, s42, -v30
  v_fma_f32 v63, v63, s42, -v30
  v_exp_f32 v48, v48
  v_exp_f32 v49, v49
  v_exp_f32 v50, v50
  v_exp_f32 v51, v51
  v_exp_f32 v52, v52
  v_exp_f32 v53, v53
  v_exp_f32 v54, v54
  v_exp_f32 v55, v55
  v_exp_f32 v56, v56
  v_exp_f32 v57, v57
  v_exp_f32 v58, v58
  v_exp_f32 v59, v59
  v_exp_f32 v60, v60
  v_exp_f32 v61, v61
  v_exp_f32 v62, v62
  v_exp_f32 v63, v63
  s_nop 0
  v_cvt_pk_bf16_f32 v64, v48, v49
  v_cvt_pk_bf16_f32 v65, v50, v51
  v_cvt_pk_bf16_f32 v66, v52, v53
  v_cvt_pk_bf16_f32 v67, v54, v55
  v_cvt_pk_bf16_f32 v68, v56, v57
  v_cvt_pk_bf16_f32 v69, v58, v59
  v_cvt_pk_bf16_f32 v70, v60, v61
  v_cvt_pk_bf16_f32 v71, v62, v63
  v_lshlrev_b32 v1, 4, v0
  s_lshl_b32 s42, s28, 14
  v_add_u32 v2, s42, v1
  ds_write_b128 v2, v[64:67]
  ds_write_b128 v2, v[68:71] offset:1024
  s_lshl_b32 s42, s28, 2
  s_add_u32 s42, s42, 161040
  v_mov_b32 v3, s42
  v_mov_b32 v4, 1
  s_waitcnt lgkmcnt(0)
  s_mov_b64 exec, 1
  ds_write_b32 v3, v4
  s_mov_b64 exec, -1
  v_mov_b32 v3, 161040
  s_mov_b32 s63, 2097152
L_prdy_36:
  s_sub_u32 s63, s63, 1
  s_cbranch_scc1 L_prdyd_37
  ds_read_b128 v[4:7], v3
  s_waitcnt lgkmcnt(0)
  v_and_b32 v4, v4, v5
  v_and_b32 v6, v6, v7
  v_and_b32 v4, v4, v6
  s_nop 0
  v_readfirstlane_b32 s45, v4
  s_cmp_eq_u32 s45, 1
  s_cbranch_scc0 L_prdy_36
L_prdyd_37:
  ds_read_b128 v[64:67], v1 offset:0
  ds_read_b128 v[68:71], v1 offset:1024
  ds_read_b128 v[72:75], v1 offset:16384
  ds_read_b128 v[76:79], v1 offset:17408
  ds_read_b128 v[80:83], v1 offset:32768
  ds_read_b128 v[84:87], v1 offset:33792
  ds_read_b128 v[88:91], v1 offset:49152
  ds_read_b128 v[92:95], v1 offset:50176
  v_mov_b32 v32, 0x3f803f80
  v_mov_b32 v33, 0x3f803f80
  v_mov_b32 v34, 0x3f803f80
  v_mov_b32 v35, 0x3f803f80
  s_add_u32 s43, s62, s37
  v_mov_b32 v3, s43
  v_cmp_eq_u32 s[44:45], s28, v0
  s_waitcnt lgkmcnt(0)
  v_mfma_f32_16x16x32_bf16 v[36:39], v[32:35], v[64:67], 0
  v_mfma_f32_16x16x32_bf16 v[36:39], v[32:35], v[68:71], v[36:39]
  v_mfma_f32_16x16x32_bf16 v[36:39], v[32:35], v[72:75], v[36:39]
  v_mfma_f32_16x16x32_bf16 v[36:39], v[32:35], v[76:79], v[36:39]
  v_mfma_f32_16x16x32_bf16 v[36:39], v[32:35], v[80:83], v[36:39]
  v_mfma_f32_16x16x32_bf16 v[36:39], v[32:35], v[84:87], v[36:39]
  v_mfma_f32_16x16x32_bf16 v[36:39], v[32:35], v[88:91], v[36:39]
  v_mfma_f32_16x16x32_bf16 v[36:39], v[32:35], v[92:95], v[36:39]
  v_mov_b32 v6, v30
  s_nop 6
  v_mov_b32 v7, v36
  s_mov_b64 exec, s[44:45]
  s_cmp_eq_u32 s37, 0
  s_cbranch_scc0 L_ml_far
  global_store_dwordx2 v3, v[6:7], s[26:27]
  s_branch L_ml_done
L_ml_far:
  global_store_dwordx2 v3, v[6:7], s[26:27] sc1
L_ml_done:
  s_mov_b64 exec, -1
  v_lshlrev_b32 v1, 12, v14
  v_bfe_u32 v2, v0, 2, 1
  v_lshl_add_u32 v1, v2, 9, v1
  v_lshrrev_b32 v3, 1, v11
  v_lshl_add_u32 v1, v3, 8, v1
  v_and_b32 v3, 1, v11
  v_lshl_add_u32 v1, v3, 3, v1
  s_lshl_b32 s42, s28, 10
  s_add_u32 s42, s42, s60
  s_add_u32 s42, s42, s37
  v_add_u32 v236, s42, v1
  v_cmp_eq_u32 s[52:53], 1, v2
  v_cmp_gt_u32 s[54:55], 8, v12
  s_lshl_b32 s42, s29, 15
  s_lshl_b32 s43, s58, 14
  s_add_u32 s42, s42, s43
  s_lshl_b32 s43, s33, 12
  s_add_u32 s42, s42, s43
  s_add_u32 s42, s42, 589824
  s_add_u32 s42, s42, s37
  v_lshlrev_b32 v1, 4, v0
  v_add_u32 v237, s42, v1
  s_lshl_b32 s42, s29, 10
  s_lshl_b32 s43, s33, 8
  s_add_u32 s42, s42, s43
  s_lshl_b32 s43, s58, 7
  s_add_u32 s42, s42, s43
  s_add_u32 s42, s42, 851968
  s_add_u32 s42, s42, s37
  v_lshlrev_b32 v2, 5, v11
  v_add_u32 v238, s42, v2
  s_lshl_b32 s42, s38, 15
  s_lshl_b32 s43, s29, 12
  s_add_u32 s42, s42, s43
  s_lshl_b32 s43, s33, 10
  s_add_u32 s42, s42, s43
  s_lshl_b32 s43, s58, 9
  s_add_u32 s42, s42, s43
  s_lshl_b32 s43, s59, 8
  s_add_u32 s42, s42, s43
  s_add_u32 s42, s42, 1179648
  v_lshlrev_b32 v1, 3, v0
  v_add_u32 v239, s42, v1
  s_lshl_b32 s42, s58, 8
  s_lshl_b32 s43, s59, 7
  s_add_u32 s42, s42, s43
  s_add_u32 s42, s42, 160000
  v_and_b32 v1, 31, v0
  v_lshlrev_b32 v1, 2, v1
  v_add_u32 v240, s42, v1
  v_and_b32 v2, 33, v0
  v_cmp_eq_u32 s[50:51], 0, v2
  v_mov_b32 v245, s35
  v_mov_b32 v247, s35
  s_cmp_ge_u32 s39, 25
  s_cbranch_scc1 L_wpd_39
  s_mov_b32 s63, 2097152
L_wp_38:
  ds_read_b32 v9, v15
  s_sub_u32 s63, s63, 1
  s_cbranch_scc1 L_wpd_39
  s_waitcnt lgkmcnt(0)
  v_readfirstlane_b32 s39, v9
  s_cmp_ge_u32 s39, 25
  s_cbranch_scc0 L_wp_38
L_wpd_39:
  ds_read_b64_tr_b16 v[96:97], v26 offset:0
  ds_read_b64_tr_b16 v[98:99], v26 offset:4096
  ds_read_b64_tr_b16 v[100:101], v27 offset:0
  ds_read_b64_tr_b16 v[102:103], v27 offset:4096
  s_cmp_ge_u32 s39, 27
  s_cbranch_scc1 L_wpd_41
  s_mov_b32 s63, 2097152
L_wp_40:
  ds_read_b32 v9, v15
  s_sub_u32 s63, s63, 1
  s_cbranch_scc1 L_wpd_41
  s_waitcnt lgkmcnt(0)
  v_readfirstlane_b32 s39, v9
  s_cmp_ge_u32 s39, 27
  s_cbranch_scc0 L_wp_40
L_wpd_41:
  ds_read_b64_tr_b16 v[104:105], v26 offset:8192
  ds_read_b64_tr_b16 v[106:107], v26 offset:12288
  ds_read_b64_tr_b16 v[108:109], v27 offset:8192
  ds_read_b64_tr_b16 v[110:111], v27 offset:12288
  s_waitcnt lgkmcnt(6)
  v_mfma_f32_16x16x32_bf16 v[40:43], v[96:99], v[64:67], 0
  s_waitcnt lgkmcnt(4)
  v_mfma_f32_16x16x32_bf16 v[44:47], v[100:103], v[64:67], 0
  s_cmp_ge_u32 s39, 29
  s_cbranch_scc1 L_wpd_43
  s_mov_b32 s63, 2097152
L_wp_42:
  ds_read_b32 v9, v15
  s_sub_u32 s63, s63, 1
  s_cbranch_scc1 L_wpd_43
  s_waitcnt lgkmcnt(0)
  v_readfirstlane_b32 s39, v9
  s_cmp_ge_u32 s39, 29
  s_cbranch_scc0 L_wp_42
L_wpd_43:
  ds_read_b64_tr_b16 v[96:97], v26 offset:16384
  ds_read_b64_tr_b16 v[98:99], v26 offset:20480
  ds_read_b64_tr_b16 v[100:101], v27 offset:16384
  ds_read_b64_tr_b16 v[102:103], v27 offset:20480
  s_waitcnt lgkmcnt(6)
  v_mfma_f32_16x16x32_bf16 v[40:43], v[104:107], v[68:71], v[40:43]
  s_waitcnt lgkmcnt(4)
  v_mfma_f32_16x16x32_bf16 v[44:47], v[108:111], v[68:71], v[44:47]
  s_cmp_ge_u32 s39, 31
  s_cbranch_scc1 L_wpd_45
  s_mov_b32 s63, 2097152
L_wp_44:
  ds_read_b32 v9, v15
  s_sub_u32 s63, s63, 1
  s_cbranch_scc1 L_wpd_45
  s_waitcnt lgkmcnt(0)
  v_readfirstlane_b32 s39, v9
  s_cmp_ge_u32 s39, 31
  s_cbranch_scc0 L_wp_44
L_wpd_45:
  ds_read_b64_tr_b16 v[104:105], v26 offset:24576
  ds_read_b64_tr_b16 v[106:107], v26 offset:28672
  ds_read_b64_tr_b16 v[108:109], v27 offset:24576
  ds_read_b64_tr_b16 v[110:111], v27 offset:28672
  s_waitcnt lgkmcnt(6)
  v_mfma_f32_16x16x32_bf16 v[40:43], v[96:99], v[72:75], v[40:43]
  s_waitcnt lgkmcnt(4)
  v_mfma_f32_16x16x32_bf16 v[44:47], v[100:103], v[72:75], v[44:47]
  s_cmp_ge_u32 s39, 33
  s_cbranch_scc1 L_wpd_47
  s_mov_b32 s63, 2097152
L_wp_46:
  ds_read_b32 v9, v15
  s_sub_u32 s63, s63, 1
  s_cbranch_scc1 L_wpd_47
  s_waitcnt lgkmcnt(0)
  v_readfirstlane_b32 s39, v9
  s_cmp_ge_u32 s39, 33
  s_cbranch_scc0 L_wp_46
L_wpd_47:
  ds_read_b64_tr_b16 v[96:97], v26 offset:32768
  ds_read_b64_tr_b16 v[98:99], v26 offset:36864
  ds_read_b64_tr_b16 v[100:101], v27 offset:32768
  ds_read_b64_tr_b16 v[102:103], v27 offset:36864
  s_waitcnt lgkmcnt(6)
  v_mfma_f32_16x16x32_bf16 v[40:43], v[104:107], v[76:79], v[40:43]
  s_waitcnt lgkmcnt(4)
  v_mfma_f32_16x16x32_bf16 v[44:47], v[108:111], v[76:79], v[44:47]
  s_cmp_lg_u32 s37, 0
  s_cbranch_scc1 L_gfar_48
  global_load_dwordx4 v[128:131], v238, s[26:27] nt
  global_load_dwordx4 v[132:135], v238, s[26:27] offset:16 nt
  s_branch L_gdone_49
L_gfar_48:
  global_load_dwordx4 v[128:131], v238, s[26:27] sc1
  global_load_dwordx4 v[132:135], v238, s[26:27] offset:16 sc1
L_gdone_49:
  s_cmp_ge_u32 s39, 35
  s_cbranch_scc1 L_wpd_51
  s_mov_b32 s63, 2097152
L_wp_50:
  ds_read_b32 v9, v15
  s_sub_u32 s63, s63, 1
  s_cbranch_scc1 L_wpd_51
  s_waitcnt lgkmcnt(0)
  v_readfirstlane_b32 s39, v9
  s_cmp_ge_u32 s39, 35
  s_cbranch_scc0 L_wp_50
L_wpd_51:
  ds_read_b64_tr_b16 v[104:105], v26 offset:40960
  ds_read_b64_tr_b16 v[106:107], v26 offset:45056
  ds_read_b64_tr_b16 v[108:109], v27 offset:40960
  ds_read_b64_tr_b16 v[110:111], v27 offset:45056
  s_waitcnt lgkmcnt(6)
  v_mfma_f32_16x16x32_bf16 v[40:43], v[96:99], v[80:83], v[40:43]
  s_waitcnt lgkmcnt(4)
  v_mfma_f32_16x16x32_bf16 v[44:47], v[100:103], v[80:83], v[44:47]
  s_cmp_ge_u32 s39, 37
  s_cbranch_scc1 L_wpd_53
  s_mov_b32 s63, 2097152
L_wp_52:
  ds_read_b32 v9, v15
  s_sub_u32 s63, s63, 1
  s_cbranch_scc1 L_wpd_53
  s_waitcnt lgkmcnt(0)
  v_readfirstlane_b32 s39, v9
  s_cmp_ge_u32 s39, 37
  s_cbranch_scc0 L_wp_52
L_wpd_53:
  ds_read_b64_tr_b16 v[96:97], v26 offset:49152
  ds_read_b64_tr_b16 v[98:99], v26 offset:53248
  ds_read_b64_tr_b16 v[100:101], v27 offset:49152
  ds_read_b64_tr_b16 v[102:103], v27 offset:53248
  s_waitcnt lgkmcnt(6)
  v_mfma_f32_16x16x32_bf16 v[40:43], v[104:107], v[84:87], v[40:43]
  s_waitcnt lgkmcnt(4)
  v_mfma_f32_16x16x32_bf16 v[44:47], v[108:111], v[84:87], v[44:47]
  s_cmp_ge_u32 s39, 39
  s_cbranch_scc1 L_wpd_55
  s_mov_b32 s63, 2097152
L_wp_54:
  ds_read_b32 v9, v15
  s_sub_u32 s63, s63, 1
  s_cbranch_scc1 L_wpd_55
  s_waitcnt lgkmcnt(0)
  v_readfirstlane_b32 s39, v9
  s_cmp_ge_u32 s39, 39
  s_cbranch_scc0 L_wp_54
L_wpd_55:
  ds_read_b64_tr_b16 v[104:105], v26 offset:57344
  ds_read_b64_tr_b16 v[106:107], v26 offset:61440
  ds_read_b64_tr_b16 v[108:109], v27 offset:57344
  ds_read_b64_tr_b16 v[110:111], v27 offset:61440
  s_waitcnt lgkmcnt(6)
  v_mfma_f32_16x16x32_bf16 v[40:43], v[96:99], v[88:91], v[40:43]
  s_waitcnt lgkmcnt(4)
  v_mfma_f32_16x16x32_bf16 v[44:47], v[100:103], v[88:91], v[44:47]
  s_waitcnt lgkmcnt(2)
  v_mfma_f32_16x16x32_bf16 v[40:43], v[104:107], v[92:95], v[40:43]
  s_waitcnt lgkmcnt(0)
  v_mfma_f32_16x16x32_bf16 v[44:47], v[108:111], v[92:95], v[44:47]
  s_nop 7
  v_cndmask_b32 v4, v40, v44, s[52:53]
  v_cndmask_b32 v5, v41, v45, s[52:53]
  v_cndmask_b32 v6, v42, v46, s[52:53]
  v_cndmask_b32 v7, v43, v47, s[52:53]
  v_cvt_pk_bf16_f32 v4, v4, v5
  v_cvt_pk_bf16_f32 v5, v6, v7
  s_mov_b64 exec, s[54:55]
  s_cmp_eq_u32 s37, 0
  s_cbranch_scc0 L_opub_far
  global_store_dwordx2 v236, v[4:5], s[26:27]
  s_branch L_opub_done
L_opub_far:
  global_store_dwordx2 v236, v[4:5], s[26:27] sc1
L_opub_done:
  s_mov_b64 exec, -1
  s_mov_b32 s44, 2097152
  s_waitcnt vmcnt(1)
L_mlpoll_56:
  v_max3_u32 v3, v128, v129, v130
  v_max3_u32 v4, v131, v132, v133
  v_max3_u32 v3, v3, v134, v135
  v_max_u32 v3, v3, v4
  v_cmp_eq_u32 vcc, -1, v3
  s_and_b64 exec, exec, vcc
  s_cbranch_execz L_mldone_57
  s_cmp_lg_u32 s37, 0
  s_cbranch_scc1 L_gfar_58
  global_load_dwordx4 v[128:131], v238, s[26:27] nt
  global_load_dwordx4 v[132:135], v238, s[26:27] offset:16 nt
  s_branch L_gdone_59
L_gfar_58:
  global_load_dwordx4 v[128:131], v238, s[26:27] sc1
  global_load_dwordx4 v[132:135], v238, s[26:27] offset:16 sc1
L_gdone_59:
  s_waitcnt vmcnt(0)
  s_sub_u32 s44, s44, 1
  s_cbranch_scc0 L_mlpoll_56
L_mldone_57:
  s_mov_b64 exec, -1
  v_max3_f32 v3, v128, v130, v132
  v_max_f32 v3, v3, v134
  v_mov_b32 v4, v3
  s_nop 1
  v_permlane16_swap_b32 v3, v4
  s_nop 1
  v_max_f32 v3, v3, v4
  v_mov_b32 v4, v3
  s_nop 1
  v_permlane32_swap_b32 v3, v4
  s_nop 1
  v_max_f32 v3, v3, v4
  v_sub_f32 v128, v128, v3
  v_sub_f32 v130, v130, v3
  v_sub_f32 v132, v132, v3
  v_sub_f32 v134, v134, v3
  v_exp_f32 v128, v128
  v_exp_f32 v130, v130
  v_exp_f32 v132, v132
  v_exp_f32 v134, v134
  s_nop 0
  v_mul_f32 v3, v128, v129
  v_fmac_f32 v3, v130, v131
  v_fmac_f32 v3, v132, v133
  v_fmac_f32 v3, v134, v135
  v_mov_b32 v4, v3
  s_nop 1
  v_permlane16_swap_b32 v3, v4
  s_nop 1
  v_add_f32 v3, v3, v4
  v_mov_b32 v4, v3
  s_nop 1
  v_permlane32_swap_b32 v3, v4
  s_nop 1
  v_add_f32 v3, v3, v4
  v_rcp_f32 v3, v3
  s_nop 0
  v_mul_f32 v3, v3, v28
  v_mul_f32 v128, v128, v3
  v_mul_f32 v130, v130, v3
  v_mul_f32 v132, v132, v3
  v_mul_f32 v134, v134, v3
  s_cmp_ge_u32 s39, 42
  s_cbranch_scc1 L_wpd_61
  s_mov_b32 s63, 2097152
L_wp_60:
  ds_read_b32 v9, v15
  s_sub_u32 s63, s63, 1
  s_cbranch_scc1 L_wpd_61
  s_waitcnt lgkmcnt(0)
  v_readfirstlane_b32 s39, v9
  s_cmp_ge_u32 s39, 42
  s_cbranch_scc0 L_wp_60
L_wpd_61:
  ds_read_b64_tr_b16 v[96:97], v18 offset:0
  ds_read_b64_tr_b16 v[98:99], v18 offset:512
  ds_read_b64_tr_b16 v[100:101], v19 offset:0
  ds_read_b64_tr_b16 v[102:103], v19 offset:512
  s_cmp_ge_u32 s39, 43
  s_cbranch_scc1 L_wpd_63
  s_mov_b32 s63, 2097152
L_wp_62:
  ds_read_b32 v9, v15
  s_sub_u32 s63, s63, 1
  s_cbranch_scc1 L_wpd_63
  s_waitcnt lgkmcnt(0)
  v_readfirstlane_b32 s39, v9
  s_cmp_ge_u32 s39, 43
  s_cbranch_scc0 L_wp_62
L_wpd_63:
  ds_read_b64_tr_b16 v[104:105], v18 offset:4096
  ds_read_b64_tr_b16 v[106:107], v18 offset:4608
  ds_read_b64_tr_b16 v[108:109], v19 offset:4096
  ds_read_b64_tr_b16 v[110:111], v19 offset:4608
  s_cmp_ge_u32 s39, 44
  s_cbranch_scc1 L_wpd_65
  s_mov_b32 s63, 2097152
L_wp_64:
  ds_read_b32 v9, v15
  s_sub_u32 s63, s63, 1
  s_cbranch_scc1 L_wpd_65
  s_waitcnt lgkmcnt(0)
  v_readfirstlane_b32 s39, v9
  s_cmp_ge_u32 s39, 44
  s_cbranch_scc0 L_wp_64
L_wpd_65:
  ds_read_b64_tr_b16 v[112:113], v18 offset:8192
  ds_read_b64_tr_b16 v[114:115], v18 offset:8704
  ds_read_b64_tr_b16 v[116:117], v19 offset:8192
  ds_read_b64_tr_b16 v[118:119], v19 offset:8704
  s_waitcnt lgkmcnt(4)
  global_load_dwordx4 v[64:67], v237, s[26:27] offset:0 sc1
  global_load_dwordx4 v[68:71], v237, s[26:27] offset:1024 sc1
  global_load_dwordx4 v[72:75], v237, s[26:27] offset:2048 sc1
  global_load_dwordx4 v[76:79], v237, s[26:27] offset:3072 sc1
  s_cmp_ge_u32 s39, 45
  s_cbranch_scc1 L_wpd_67
  s_mov_b32 s63, 2097152
L_wp_66:
  ds_read_b32 v9, v15
  s_sub_u32 s63, s63, 1
  s_cbranch_scc1 L_wpd_67
  s_waitcnt lgkmcnt(0)
  v_readfirstlane_b32 s39, v9
  s_cmp_ge_u32 s39, 45
  s_cbranch_scc0 L_wp_66
L_wpd_67:
  ds_read_b64_tr_b16 v[120:121], v18 offset:12288
  ds_read_b64_tr_b16 v[122:123], v18 offset:12800
  ds_read_b64_tr_b16 v[124:125], v19 offset:12288
  ds_read_b64_tr_b16 v[126:127], v19 offset:12800
  v_mov_b32 v8, 161064
  s_mov_b32 s63, 2097152
L_wf_68:
  s_sub_u32 s63, s63, 1
  s_cbranch_scc1 L_wfd_69
  ds_read_b32 v9, v8
  s_waitcnt lgkmcnt(0)
  v_readfirstlane_b32 s45, v9
  s_cmp_ge_u32 s45, 1
  s_cbranch_scc0 L_wf_68
L_wfd_69:
  ds_read_b32 v241, v240
  s_mov_b32 s44, 2097152
L_opoll_70:
  s_waitcnt vmcnt(0)
  v_max3_u32 v3, v64, v65, v66
  v_max3_u32 v4, v67, v68, v69
  v_max3_u32 v5, v70, v71, v72
  v_max3_u32 v6, v73, v74, v75
  v_max3_u32 v3, v3, v76, v77
  v_max3_u32 v4, v4, v78, v79
  v_max3_u32 v3, v3, v5, v6
  v_max_u32 v3, v3, v4
  v_cmp_eq_u32 vcc, -1, v3
  s_and_b64 exec, exec, vcc
  s_cbranch_execz L_odone_71
  global_load_dwordx4 v[64:67], v237, s[26:27] offset:0 sc1
  global_load_dwordx4 v[68:71], v237, s[26:27] offset:1024 sc1
  global_load_dwordx4 v[72:75], v237, s[26:27] offset:2048 sc1
  global_load_dwordx4 v[76:79], v237, s[26:27] offset:3072 sc1
  s_sub_u32 s44, s44, 1
  s_cbranch_scc0 L_opoll_70
L_odone_71:
  s_mov_b64 exec, -1
  s_waitcnt lgkmcnt(0)
  v_mfma_f32_16x16x32_bf16 v[88:91], v[64:67], v[96:99], 0
  v_mfma_f32_16x16x32_bf16 v[92:95], v[64:67], v[100:103], 0
  v_mfma_f32_16x16x32_bf16 v[88:91], v[68:71], v[104:107], v[88:91]
  v_mfma_f32_16x16x32_bf16 v[92:95], v[68:71], v[108:111], v[92:95]
  v_mfma_f32_16x16x32_bf16 v[88:91], v[72:75], v[112:115], v[88:91]
  v_mfma_f32_16x16x32_bf16 v[92:95], v[72:75], v[116:119], v[92:95]
  v_mfma_f32_16x16x32_bf16 v[88:91], v[76:79], v[120:123], v[88:91]
  v_mfma_f32_16x16x32_bf16 v[92:95], v[76:79], v[124:127], v[92:95]
  v_mul_f32 v241, v29, v241
  s_nop 6
  v_mul_f32 v4, v128, v88
  v_mul_f32 v5, v128, v92
  v_fmac_f32 v4, v130, v89
  v_fmac_f32 v5, v130, v93
  v_fmac_f32 v4, v132, v90
  v_fmac_f32 v5, v132, v94
  v_fmac_f32 v4, v134, v91
  v_fmac_f32 v5, v134, v95
  s_nop 1
  v_permlane16_swap_b32 v4, v5
  s_nop 1
  v_add_f32 v4, v4, v5
  v_mov_b32 v5, v4
  s_nop 1
  v_permlane32_swap_b32 v4, v5
  s_nop 1
  v_add_f32 v244, v4, v5
  v_add_f32 v244, v244, v241
  s_nop 1
  v_mov_b32_dpp v246, v244 quad_perm:[1,0,3,2] row_mask:0xf bank_mask:0xf
  s_mov_b64 exec, s[50:51]
  global_store_dwordx4 v239, v[244:247], s[26:27] sc1
  s_mov_b64 exec, 1
  v_mov_b32 v1, 161060
  v_mov_b32 v2, 1
  ds_add_u32 v1, v2
  s_mov_b64 exec, -1
L_fin:
L_end:
  s_endpgm
.section .rodata,"a"
.p2align 6
.amdhsa_kernel gated_mix__sliding_block_cached__dense_activation_silu__decode_kernel
  .amdhsa_next_free_vgpr 256
  .amdhsa_next_free_sgpr 102
  .amdhsa_accum_offset 256
  .amdhsa_group_segment_fixed_size 0
  .amdhsa_kernarg_size 96
  .amdhsa_user_sgpr_count 2
  .amdhsa_user_sgpr_kernarg_segment_ptr 1
  .amdhsa_system_sgpr_workgroup_id_x 1
.end_amdhsa_kernel
```
